```python
import torch

def _softmax(x, axis=-1):
    return torch.softmax(x, dim=axis)

def _gelu(x):
    return torch.nn.functional.gelu(x, approximate='tanh')

def _silu(x):
    return torch.nn.functional.silu(x)

def _sigmoid(x):
    return torch.sigmoid(x)

def _layernorm(x, axis=-1, eps=1e-05):
    m = x.mean(dim=axis, keepdim=True)
    v = x.var(dim=axis, keepdim=True, unbiased=False)
    return (x - m) / torch.sqrt(v + eps)

def _scatter_add(tgt, idx, src, axis=0):
    return tgt.clone().index_add_(axis, idx, src)

def _segment_sum(src, seg, n):
    out = torch.zeros((n,) + src.shape[1:], dtype=src.dtype)
    return out.index_add_(0, seg, src)

def _pad(x, pw):
    flat = tuple((v for pair in reversed(pw) for v in pair))
    return torch.nn.functional.pad(x, flat)
kernel_name = 'standalone__molecular_angular_painn__graph'

def setup_inputs():

    _w = lambda a: (lambda t: t.to(torch.bfloat16) if t.is_floating_point() else t)(torch.as_tensor(a))
    N, deg, D = (25000, 16, 128)
    n_rbf = max(4, 4)
    E = N * deg
    cutoff = 5.0
    freqs = (torch.arange(1, n_rbf + 1) * torch.pi / cutoff).to(float)
    return {'sv': _w((lambda *s: torch.randn(*s, dtype=torch.bfloat16) * 0.4)(N, 4, D) * 0.3), 'pos': _w((lambda *s: torch.randn(*s, dtype=torch.bfloat16) * 3.2)(N, 3) * 1.2), 'src': _w((lambda lo, hi, *s: torch.randint(lo, hi, s))(0, N, E).to(torch.int64)), 'dst': _w((lambda lo, hi, *s: torch.randint(lo, hi, s))(0, N, E).to(torch.int64)), 'freqs': _w(freqs), 'w_phi1': _w((lambda *s: torch.randn(*s, dtype=torch.bfloat16) * 3.2)(D, D) / D ** 0.5), 'w_phi2': _w((lambda *s: torch.randn(*s, dtype=torch.bfloat16) * 3.2)(D, 3 * D) / D ** 0.5), 'w_rbf': _w((lambda *s: torch.randn(*s, dtype=torch.bfloat16) * 3.2)(n_rbf, 3 * D) / n_rbf ** 0.5)}

def reference(sv, pos, src, dst, freqs, w_phi1, w_phi2, w_rbf):
    N, _, D = sv.shape
    E = src.shape[0]
    PI, cutoff = (3.141592653589793, 5.0)
    s, v = (sv[:, 0, :].clone(), sv[:, 1:, :].clone())
    r_vec = pos[src] - pos[dst]
    d = torch.sqrt((r_vec * r_vec).sum(-1) + 1e-08)
    r_hat = r_vec / d[:, None]
    rbf = torch.sin(d[:, None] * freqs[None, :]) / d[:, None]
    fcut = 0.5 * (torch.cos(PI * d / cutoff) + 1.0)
    fcut = torch.where(d < cutoff, fcut, 0.0 * d)
    Wf = rbf @ w_rbf * fcut[:, None]
    phi = (_silu(s @ w_phi1) @ w_phi2)[src]
    m = phi * Wf
    m_s, m_vv, m_vr = (m[:, :D].clone(), m[:, D:2 * D].clone(), m[:, 2 * D:].clone())
    ds = _segment_sum(m_s, dst, N)
    dv_e = m_vv[:, None, :] * v[src] + m_vr[:, None, :] * r_hat[:, :, None]
    dv = _segment_sum(dv_e.reshape(E, 3 * D), dst, N).reshape(N, 3, D)
    return sv + torch.concatenate([ds[:, None, :], dv], axis=1)
```

```asm
; @launch kernel=k1_kernel grid=(250,1,1) block=(1024,1,1) lds=155648
; @launch kernel=k2_kernel grid=(256,1,1) block=(512,1,1) lds=162928
.amdgcn_target "amdgcn-amd-amdhsa--gfx950"
.text
.p2align 8
k1_kernel:
    s_cmp_ge_u32 s2, 250
    s_cbranch_scc1 K1_END
    s_load_dwordx8 s[64:71], s[0:1], 0
    s_load_dwordx2 s[10:11], s[0:1], 80
    s_load_dwordx4 s[40:43], s[0:1], 40
    s_load_dwordx2 s[44:45], s[0:1], 56
    v_lshrrev_b32 v1, 6, v0
    s_nop 0
    v_readfirstlane_b32 s3, v1
    v_and_b32 v2, 63, v0
    v_lshlrev_b32 v12, 4, v2
    s_add_u32 s28, s2, 112
    s_sub_u32 s29, s2, 131
    s_cmp_lt_u32 s2, 131
    s_cselect_b32 s28, s28, s29
    s_cmp_lt_u32 s2, 243
    s_cselect_b32 s2, s28, s2
    s_cmp_ge_u32 s2, 112
    s_cbranch_scc1 K1_NODE
    s_mul_i32 s28, s2, 14304
    v_lshlrev_b32 v3, 4, v0
    s_movk_i32 s32, 894
    v_cmp_gt_u32 s[34:35], s32, v0
    v_add_u32 v3, s28, v3
    s_mov_b32 s32, 1600000
    v_cmp_gt_u32 vcc, s32, v3
    s_nop 0
    s_and_b64 s[34:35], s[34:35], vcc
    s_lshl_b32 s29, s3, 12
    s_waitcnt lgkmcnt(0)
    s_mov_b32 s16, s68
    s_and_b32 s17, s69, 0xffff
    s_mov_b32 s18, 1600000
    s_mov_b32 s19, 0x00020000
    s_mov_b32 s20, s70
    s_and_b32 s21, s71, 0xffff
    s_mov_b32 s22, 1600000
    s_mov_b32 s23, 0x00020000
    buffer_load_dwordx4 v[4:7], v3, s[16:19], 0 offen nt
    buffer_load_dwordx4 v[8:11], v3, s[20:23], 0 offen nt
    s_mov_b32 s12, s66
    s_and_b32 s13, s67, 0xffff
    s_mov_b32 s14, 150000
    s_mov_b32 s15, 0x00020000
    s_lshr_b32 s29, s2, 3
    s_mul_i32 s29, s29, 8
    s_add_u32 s29, s29, s3
    s_mul_hi_u32 s30, s29, 116080198
    s_mul_i32 s30, s30, 37
    s_sub_u32 s29, s29, s30
    s_lshl_b32 s29, s29, 12
    s_mov_b32 m0, s29
    s_nop 0
    buffer_load_dwordx4 v12, s[12:15], s29 offen offset:0 lds
    buffer_load_dwordx4 v12, s[12:15], s29 offen offset:1024 lds
    buffer_load_dwordx4 v12, s[12:15], s29 offen offset:2048 lds
    buffer_load_dwordx4 v12, s[12:15], s29 offen offset:3072 lds
    s_add_u32 s29, s29, 65536
    s_cmp_ge_u32 s29, 151552
    s_cselect_b32 s30, 151552, 0
    s_sub_u32 s29, s29, s30
    s_mov_b32 m0, s29
    s_nop 0
    buffer_load_dwordx4 v12, s[12:15], s29 offen offset:0 lds
    buffer_load_dwordx4 v12, s[12:15], s29 offen offset:1024 lds
    buffer_load_dwordx4 v12, s[12:15], s29 offen offset:2048 lds
    buffer_load_dwordx4 v12, s[12:15], s29 offen offset:3072 lds
    s_add_u32 s29, s29, 65536
    s_cmp_ge_u32 s29, 151552
    s_cselect_b32 s30, 151552, 0
    s_sub_u32 s29, s29, s30
    s_cmp_ge_u32 s3, 5
    s_cbranch_scc1 K1_DMA_DONE
    s_mov_b32 m0, s29
    s_nop 0
    buffer_load_dwordx4 v12, s[12:15], s29 offen offset:0 lds
    buffer_load_dwordx4 v12, s[12:15], s29 offen offset:1024 lds
    buffer_load_dwordx4 v12, s[12:15], s29 offen offset:2048 lds
    buffer_load_dwordx4 v12, s[12:15], s29 offen offset:3072 lds
    s_add_u32 s29, s29, 65536
    s_cmp_ge_u32 s29, 151552
    s_cselect_b32 s30, 151552, 0
    s_sub_u32 s29, s29, s30
K1_DMA_DONE:
    s_mov_b32 s24, s10
    s_and_b32 s25, s11, 0xffff
    s_mov_b32 s26, 20971520
    s_mov_b32 s27, 0x00020000
    v_mov_b32 v13, 0
    v_lshlrev_b32 v14, 2, v0
    v_cmp_gt_u32 vcc, 260, v0
    s_nop 0
    s_and_saveexec_b64 s[30:31], vcc
    v_add_u32 v15, 151552, v14
    ds_write_b32 v15, v13
    s_mov_b64 exec, s[30:31]
    s_mov_b32 s33, 43826197
    s_mov_b32 s36, 0x41c20000
    s_mov_b32 s37, 0xffff0000
    s_waitcnt vmcnt(0) lgkmcnt(0)
    s_barrier
    s_mov_b64 s[46:47], 0
    s_mov_b64 s[48:49], 0
    s_mov_b64 s[50:51], 0
    s_mov_b64 s[52:53], 0
    v_mov_b32 v13, 1
    s_cmp_eq_u64 s[34:35], 0
    s_nop 0
    s_cbranch_scc1 K1_NOEDGE
    v_mul_u32_u24 v16, 6, v4
    v_and_b32 v16, -4, v16
    v_mul_u32_u24 v17, 6, v5
    v_and_b32 v17, -4, v17
    v_mul_u32_u24 v18, 6, v6
    v_and_b32 v18, -4, v18
    v_mul_u32_u24 v19, 6, v7
    v_and_b32 v19, -4, v19
    v_mul_u32_u24 v20, 6, v8
    v_and_b32 v20, -4, v20
    v_mul_u32_u24 v21, 6, v9
    v_and_b32 v21, -4, v21
    v_mul_u32_u24 v22, 6, v10
    v_and_b32 v22, -4, v22
    v_mul_u32_u24 v23, 6, v11
    v_and_b32 v23, -4, v23
    ds_read2_b32 v[24:25], v16 offset0:0 offset1:1
    ds_read2_b32 v[26:27], v17 offset0:0 offset1:1
    ds_read2_b32 v[28:29], v18 offset0:0 offset1:1
    ds_read2_b32 v[30:31], v19 offset0:0 offset1:1
    ds_read2_b32 v[32:33], v20 offset0:0 offset1:1
    ds_read2_b32 v[34:35], v21 offset0:0 offset1:1
    ds_read2_b32 v[36:37], v22 offset0:0 offset1:1
    ds_read2_b32 v[38:39], v23 offset0:0 offset1:1
    v_and_b32 v16, 1, v4
    v_lshlrev_b32 v16, 4, v16
    v_and_b32 v17, 1, v5
    v_lshlrev_b32 v17, 4, v17
    v_and_b32 v18, 1, v6
    v_lshlrev_b32 v18, 4, v18
    v_and_b32 v19, 1, v7
    v_lshlrev_b32 v19, 4, v19
    v_and_b32 v20, 1, v8
    v_lshlrev_b32 v20, 4, v20
    v_and_b32 v21, 1, v9
    v_lshlrev_b32 v21, 4, v21
    v_and_b32 v22, 1, v10
    v_lshlrev_b32 v22, 4, v22
    v_and_b32 v23, 1, v11
    v_lshlrev_b32 v23, 4, v23
    v_mul_hi_u32 v44, v8, s33
    v_lshl_or_b32 v48, v8, 16, v4
    v_lshlrev_b32 v52, 2, v44
    v_add_u32 v52, 151552, v52
    v_mul_hi_u32 v45, v9, s33
    v_lshl_or_b32 v49, v9, 16, v5
    v_lshlrev_b32 v53, 2, v45
    v_add_u32 v53, 151552, v53
    v_mul_hi_u32 v46, v10, s33
    v_lshl_or_b32 v50, v10, 16, v6
    v_lshlrev_b32 v54, 2, v46
    v_add_u32 v54, 151552, v54
    v_mul_hi_u32 v47, v11, s33
    v_lshl_or_b32 v51, v11, 16, v7
    v_lshlrev_b32 v55, 2, v47
    v_add_u32 v55, 151552, v55
    s_waitcnt lgkmcnt(0)
    v_alignbit_b32 v24, v25, v24, v16
    v_lshrrev_b32 v25, v16, v25
    v_alignbit_b32 v26, v27, v26, v17
    v_lshrrev_b32 v27, v17, v27
    v_alignbit_b32 v28, v29, v28, v18
    v_lshrrev_b32 v29, v18, v29
    v_alignbit_b32 v30, v31, v30, v19
    v_lshrrev_b32 v31, v19, v31
    v_alignbit_b32 v32, v33, v32, v20
    v_lshrrev_b32 v33, v20, v33
    v_alignbit_b32 v34, v35, v34, v21
    v_lshrrev_b32 v35, v21, v35
    v_alignbit_b32 v36, v37, v36, v22
    v_lshrrev_b32 v37, v22, v37
    v_alignbit_b32 v38, v39, v38, v23
    v_lshrrev_b32 v39, v23, v39
    v_lshlrev_b32 v40, 16, v24
    v_lshlrev_b32 v41, 16, v32
    v_sub_f32 v40, v40, v41
    v_and_b32 v41, s37, v24
    v_and_b32 v42, s37, v32
    v_sub_f32 v41, v41, v42
    v_lshlrev_b32 v42, 16, v25
    v_lshlrev_b32 v43, 16, v33
    v_sub_f32 v42, v42, v43
    v_mul_f32 v40, v40, v40
    v_fmac_f32 v40, v41, v41
    v_fmac_f32 v40, v42, v42
    v_cmp_nle_f32 s[46:47], s36, v40
    v_lshlrev_b32 v40, 16, v26
    v_lshlrev_b32 v41, 16, v34
    v_sub_f32 v40, v40, v41
    v_and_b32 v41, s37, v26
    v_and_b32 v42, s37, v34
    v_sub_f32 v41, v41, v42
    v_lshlrev_b32 v42, 16, v27
    v_lshlrev_b32 v43, 16, v35
    v_sub_f32 v42, v42, v43
    v_mul_f32 v40, v40, v40
    v_fmac_f32 v40, v41, v41
    v_fmac_f32 v40, v42, v42
    v_cmp_nle_f32 s[48:49], s36, v40
    v_lshlrev_b32 v40, 16, v28
    v_lshlrev_b32 v41, 16, v36
    v_sub_f32 v40, v40, v41
    v_and_b32 v41, s37, v28
    v_and_b32 v42, s37, v36
    v_sub_f32 v41, v41, v42
    v_lshlrev_b32 v42, 16, v29
    v_lshlrev_b32 v43, 16, v37
    v_sub_f32 v42, v42, v43
    v_mul_f32 v40, v40, v40
    v_fmac_f32 v40, v41, v41
    v_fmac_f32 v40, v42, v42
    v_cmp_nle_f32 s[50:51], s36, v40
    v_lshlrev_b32 v40, 16, v30
    v_lshlrev_b32 v41, 16, v38
    v_sub_f32 v40, v40, v41
    v_and_b32 v41, s37, v30
    v_and_b32 v42, s37, v38
    v_sub_f32 v41, v41, v42
    v_lshlrev_b32 v42, 16, v31
    v_lshlrev_b32 v43, 16, v39
    v_sub_f32 v42, v42, v43
    v_mul_f32 v40, v40, v40
    v_fmac_f32 v40, v41, v41
    v_fmac_f32 v40, v42, v42
    v_cmp_nle_f32 s[52:53], s36, v40
    s_and_b64 s[46:47], s[46:47], s[34:35]
    s_and_b64 s[48:49], s[48:49], s[34:35]
    s_and_b64 s[50:51], s[50:51], s[34:35]
    s_and_b64 s[52:53], s[52:53], s[34:35]
    s_mov_b64 exec, s[46:47]
    ds_add_rtn_u32 v56, v52, v13
    s_mov_b64 exec, s[48:49]
    ds_add_rtn_u32 v57, v53, v13
    s_mov_b64 exec, s[50:51]
    ds_add_rtn_u32 v58, v54, v13
    s_mov_b64 exec, s[52:53]
    ds_add_rtn_u32 v59, v55, v13
    s_mov_b64 exec, -1
K1_NOEDGE:
    s_waitcnt lgkmcnt(0)
    s_barrier
    s_mov_b64 s[54:55], 0
    v_cmp_le_u32 vcc, 7, v56
    s_nop 1
    v_addc_co_u32 v52, vcc, 1, v56, vcc
    v_lshlrev_b32 v52, 2, v52
    v_lshl_add_u32 v52, v44, 6, v52
    v_cmp_gt_u32 vcc, 14, v56
    s_nop 0
    s_andn2_b64 s[56:57], s[46:47], vcc
    s_or_b64 s[54:55], s[54:55], s[56:57]
    s_and_b64 exec, s[46:47], vcc
    ds_write_b32 v52, v48
    s_mov_b64 exec, -1
    v_cmp_le_u32 vcc, 7, v57
    s_nop 1
    v_addc_co_u32 v53, vcc, 1, v57, vcc
    v_lshlrev_b32 v53, 2, v53
    v_lshl_add_u32 v53, v45, 6, v53
    v_cmp_gt_u32 vcc, 14, v57
    s_nop 0
    s_andn2_b64 s[58:59], s[48:49], vcc
    s_or_b64 s[54:55], s[54:55], s[58:59]
    s_and_b64 exec, s[48:49], vcc
    ds_write_b32 v53, v49
    s_mov_b64 exec, -1
    v_cmp_le_u32 vcc, 7, v58
    s_nop 1
    v_addc_co_u32 v54, vcc, 1, v58, vcc
    v_lshlrev_b32 v54, 2, v54
    v_lshl_add_u32 v54, v46, 6, v54
    v_cmp_gt_u32 vcc, 14, v58
    s_nop 0
    s_andn2_b64 s[60:61], s[50:51], vcc
    s_or_b64 s[54:55], s[54:55], s[60:61]
    s_and_b64 exec, s[50:51], vcc
    ds_write_b32 v54, v50
    s_mov_b64 exec, -1
    v_cmp_le_u32 vcc, 7, v59
    s_nop 1
    v_addc_co_u32 v55, vcc, 1, v59, vcc
    v_lshlrev_b32 v55, 2, v55
    v_lshl_add_u32 v55, v47, 6, v55
    v_cmp_gt_u32 vcc, 14, v59
    s_nop 0
    s_andn2_b64 s[62:63], s[52:53], vcc
    s_or_b64 s[54:55], s[54:55], s[62:63]
    s_and_b64 exec, s[52:53], vcc
    ds_write_b32 v55, v51
    s_mov_b64 exec, -1
    s_cmp_eq_u64 s[54:55], 0
    s_cbranch_scc1 K1_NOOVF
    v_mov_b32 v40, 152576
    s_mul_i32 s28, s2, 16384
    s_add_u32 s28, s28, 2097168
    s_mov_b64 exec, s[56:57]
    s_cbranch_execz K1_OV0
    ds_add_rtn_u32 v41, v40, v13
    s_waitcnt lgkmcnt(0)
    v_lshlrev_b32 v41, 2, v41
    buffer_store_dword v48, v41, s[24:27], s28 offen
    s_nop 0
K1_OV0:
    s_mov_b64 exec, s[58:59]
    s_cbranch_execz K1_OV1
    ds_add_rtn_u32 v41, v40, v13
    s_waitcnt lgkmcnt(0)
    v_lshlrev_b32 v41, 2, v41
    buffer_store_dword v49, v41, s[24:27], s28 offen
    s_nop 0
K1_OV1:
    s_mov_b64 exec, s[60:61]
    s_cbranch_execz K1_OV2
    ds_add_rtn_u32 v41, v40, v13
    s_waitcnt lgkmcnt(0)
    v_lshlrev_b32 v41, 2, v41
    buffer_store_dword v50, v41, s[24:27], s28 offen
    s_nop 0
K1_OV2:
    s_mov_b64 exec, s[62:63]
    s_cbranch_execz K1_OV3
    ds_add_rtn_u32 v41, v40, v13
    s_waitcnt lgkmcnt(0)
    v_lshlrev_b32 v41, 2, v41
    buffer_store_dword v51, v41, s[24:27], s28 offen
    s_nop 0
K1_OV3:
    s_mov_b64 exec, -1
K1_NOOVF:
    v_lshlrev_b32 v44, 4, v0
    v_and_b32 v48, -4, v0
    v_add_u32 v48, 151552, v48
    v_mov_b32 v56, 152576
    v_and_b32 v55, 1, v0
    v_cmp_eq_u32 s[34:35], 0, v55
    s_mul_i32 s28, s2, 16384
    s_waitcnt lgkmcnt(0)
    s_barrier
    ds_read_b128 v[16:19], v44
    ds_read_b32 v52, v48
    ds_read_b32 v57, v56
    s_waitcnt lgkmcnt(0)
    v_cndmask_b32 v16, v16, v52, s[34:35]
    buffer_store_dwordx4 v[16:19], v44, s[24:27], s28 offen
    v_cmp_eq_u32 vcc, 0, v0
    s_nop 0
    s_and_b64 exec, exec, vcc
    s_nop 2
    s_cbranch_execz K1_END
    s_mul_i32 s28, s2, 16384
    s_add_u32 s28, s28, 2097152
    buffer_store_dword v57, v0, s[24:27], s28 offen
    s_endpgm
K1_NODE:
    v_and_b32 v3, 15, v2
    v_lshrrev_b32 v4, 4, v2
    s_cmp_ge_u32 s2, 243
    s_nop 0
    s_cbranch_scc1 K1_PREP
    s_sub_u32 s28, s2, 112
    s_mul_i32 s28, s28, 192
    v_xor_b32 v5, v3, v4
    v_lshlrev_b32 v5, 4, v5
    v_lshl_add_u32 v6, v4, 8, v5
    v_lshl_add_u32 v5, v4, 10, v5
    v_and_b32 v7, 1, v4
    v_lshlrev_b32 v7, 1, v7
    v_lshrrev_b32 v8, 1, v4
    v_lshl_add_u32 v7, v8, 3, v7
    v_xor_b32 v7, v7, v3
    v_lshlrev_b32 v7, 4, v7
    v_lshl_add_u32 v7, v4, 8, v7
    s_waitcnt lgkmcnt(0)
    s_mov_b32 s12, s64
    s_and_b32 s13, s65, 0xffff
    s_mov_b32 s14, 25600000
    s_mov_b32 s15, 0x00020000
    s_mov_b32 s16, s40
    s_and_b32 s17, s41, 0xffff
    s_mov_b32 s18, 32768
    s_mov_b32 s19, 0x00020000
    s_add_u32 s29, s3, 0
    s_lshl_b32 s30, s29, 10
    s_lshr_b32 s31, s29, 1
    s_lshl_b32 s31, s31, 6
    s_add_u32 m0, s30, s31
    s_nop 0
    buffer_load_dwordx4 v7, s[16:19], s30 offen lds
    s_add_u32 s29, s3, 16
    s_lshl_b32 s30, s29, 10
    s_lshr_b32 s31, s29, 1
    s_lshl_b32 s31, s31, 6
    s_add_u32 m0, s30, s31
    s_nop 0
    buffer_load_dwordx4 v7, s[16:19], s30 offen lds
    s_add_u32 s29, s3, 0
    s_mul_i32 s30, s29, 1088
    s_add_u32 m0, s30, 33792
    s_lshl_b32 s30, s29, 2
    s_add_u32 s30, s30, s28
    s_lshl_b32 s30, s30, 10
    buffer_load_dwordx4 v5, s[12:15], s30 offen nt lds
    s_add_u32 s29, s3, 16
    s_mul_i32 s30, s29, 1088
    s_add_u32 m0, s30, 33792
    s_lshl_b32 s30, s29, 2
    s_add_u32 s30, s30, s28
    s_lshl_b32 s30, s30, 10
    buffer_load_dwordx4 v5, s[12:15], s30 offen nt lds
    s_add_u32 s29, s3, 32
    s_mul_i32 s30, s29, 1088
    s_add_u32 m0, s30, 33792
    s_lshl_b32 s30, s29, 2
    s_add_u32 s30, s30, s28
    s_lshl_b32 s30, s30, 10
    buffer_load_dwordx4 v5, s[12:15], s30 offen nt lds
K1_SD:
    s_mov_b32 s24, s10
    s_and_b32 s25, s11, 0xffff
    s_mov_b32 s26, 14788608
    s_mov_b32 s27, 0x00020000
    s_and_b32 s29, s3, 7
    s_lshr_b32 s30, s3, 3
    v_lshrrev_b32 v8, 2, v3
    v_and_b32 v9, 3, v3
    v_and_b32 v10, 1, v8
    v_lshlrev_b32 v10, 1, v10
    v_lshrrev_b32 v11, 1, v8
    v_lshl_add_u32 v10, v11, 3, v10
    s_lshl_b32 s31, s29, 1
    v_lshrrev_b32 v11, 1, v9
    v_add_u32 v11, s31, v11
    v_xor_b32 v10, v10, v11
    v_lshlrev_b32 v10, 4, v10
    v_and_b32 v11, 1, v9
    v_lshl_add_u32 v10, v11, 3, v10
    v_lshl_add_u32 v10, v8, 8, v10
    v_mul_u32_u24 v11, 2112, v4
    v_add_u32 v10, v10, v11
    v_xor_b32 v11, v4, v9
    v_lshlrev_b32 v11, 4, v11
    v_lshl_add_u32 v11, v9, 8, v11
    v_mul_u32_u24 v13, 1088, v8
    v_add_u32 v11, v11, v13
    s_mul_i32 s32, s30, 26112
    s_add_u32 s33, s32, 33792
    v_add_u32 v11, s33, v11
    v_lshrrev_b32 v14, 1, v4
    v_add_u32 v14, s31, v14
    v_xor_b32 v14, v14, v9
    v_lshlrev_b32 v14, 4, v14
    v_and_b32 v15, 1, v4
    v_lshl_add_u32 v14, v15, 3, v14
    v_lshl_add_u32 v14, v9, 8, v14
    v_add_u32 v14, v14, v13
    s_add_u32 s33, s32, 94720
    v_add_u32 v14, s33, v14
    s_mov_b32 s34, 0xbfb8aa3b
    s_waitcnt vmcnt(0)
    s_barrier
    ds_read_b64_tr_b16 v[16:17], v10 offset:0
    ds_read_b64_tr_b16 v[18:19], v10 offset:1024
    ds_read_b64_tr_b16 v[20:21], v10 offset:8448
    ds_read_b64_tr_b16 v[22:23], v10 offset:9472
    ds_read_b64_tr_b16 v[24:25], v10 offset:16896
    ds_read_b64_tr_b16 v[26:27], v10 offset:17920
    ds_read_b64_tr_b16 v[28:29], v10 offset:25344
    ds_read_b64_tr_b16 v[30:31], v10 offset:26368
    ds_read_b128 v[32:35], v11 offset:0
    ds_read_b128 v[36:39], v11 offset:64
    ds_read_b128 v[40:43], v11 offset:128
    ds_read_b128 v[44:47], v11 offset:192
    ds_read_b128 v[48:51], v11 offset:4352
    ds_read_b128 v[52:55], v11 offset:4416
    ds_read_b128 v[56:59], v11 offset:4480
    ds_read_b128 v[60:63], v11 offset:4544
    ds_read_b128 v[64:67], v11 offset:8704
    ds_read_b128 v[68:71], v11 offset:8768
    ds_read_b128 v[72:75], v11 offset:8832
    ds_read_b128 v[76:79], v11 offset:8896
    s_waitcnt lgkmcnt(8)
    v_mfma_f32_16x16x32_bf16 v[96:99], v[16:19], v[32:35], 0
    v_mfma_f32_16x16x32_bf16 v[96:99], v[20:23], v[36:39], v[96:99]
    v_mfma_f32_16x16x32_bf16 v[96:99], v[24:27], v[40:43], v[96:99]
    v_mfma_f32_16x16x32_bf16 v[96:99], v[28:31], v[44:47], v[96:99]
    s_waitcnt lgkmcnt(4)
    v_mfma_f32_16x16x32_bf16 v[100:103], v[16:19], v[48:51], 0
    v_mfma_f32_16x16x32_bf16 v[100:103], v[20:23], v[52:55], v[100:103]
    v_mfma_f32_16x16x32_bf16 v[100:103], v[24:27], v[56:59], v[100:103]
    v_mfma_f32_16x16x32_bf16 v[100:103], v[28:31], v[60:63], v[100:103]
    s_waitcnt lgkmcnt(0)
    v_mfma_f32_16x16x32_bf16 v[104:107], v[16:19], v[64:67], 0
    v_mfma_f32_16x16x32_bf16 v[104:107], v[20:23], v[68:71], v[104:107]
    v_mfma_f32_16x16x32_bf16 v[104:107], v[24:27], v[72:75], v[104:107]
    v_mfma_f32_16x16x32_bf16 v[104:107], v[28:31], v[76:79], v[104:107]
    v_mul_f32 v112, s34, v96
    v_mul_f32 v113, s34, v97
    v_mul_f32 v114, s34, v98
    v_mul_f32 v115, s34, v99
    v_mul_f32 v116, s34, v100
    v_mul_f32 v117, s34, v101
    v_mul_f32 v118, s34, v102
    v_mul_f32 v119, s34, v103
    v_mul_f32 v120, s34, v104
    v_mul_f32 v121, s34, v105
    v_mul_f32 v122, s34, v106
    v_mul_f32 v123, s34, v107
    v_exp_f32 v112, v112
    v_exp_f32 v113, v113
    v_exp_f32 v114, v114
    v_exp_f32 v115, v115
    v_exp_f32 v116, v116
    v_exp_f32 v117, v117
    v_exp_f32 v118, v118
    v_exp_f32 v119, v119
    v_exp_f32 v120, v120
    v_exp_f32 v121, v121
    v_exp_f32 v122, v122
    v_exp_f32 v123, v123
    v_add_f32 v112, 1.0, v112
    v_add_f32 v113, 1.0, v113
    v_add_f32 v114, 1.0, v114
    v_add_f32 v115, 1.0, v115
    v_add_f32 v116, 1.0, v116
    v_add_f32 v117, 1.0, v117
    v_add_f32 v118, 1.0, v118
    v_add_f32 v119, 1.0, v119
    v_add_f32 v120, 1.0, v120
    v_add_f32 v121, 1.0, v121
    v_add_f32 v122, 1.0, v122
    v_add_f32 v123, 1.0, v123
    v_rcp_f32 v112, v112
    v_rcp_f32 v113, v113
    v_rcp_f32 v114, v114
    v_rcp_f32 v115, v115
    v_rcp_f32 v116, v116
    v_rcp_f32 v117, v117
    v_rcp_f32 v118, v118
    v_rcp_f32 v119, v119
    v_rcp_f32 v120, v120
    v_rcp_f32 v121, v121
    v_rcp_f32 v122, v122
    v_rcp_f32 v123, v123
    v_mul_f32 v96, v96, v112
    v_mul_f32 v97, v97, v113
    v_mul_f32 v98, v98, v114
    v_mul_f32 v99, v99, v115
    v_mul_f32 v100, v100, v116
    v_mul_f32 v101, v101, v117
    v_mul_f32 v102, v102, v118
    v_mul_f32 v103, v103, v119
    v_mul_f32 v104, v104, v120
    v_mul_f32 v105, v105, v121
    v_mul_f32 v106, v106, v122
    v_mul_f32 v107, v107, v123
    v_cvt_pk_bf16_f32 v112, v96, v97
    v_cvt_pk_bf16_f32 v113, v98, v99
    v_cvt_pk_bf16_f32 v114, v100, v101
    v_cvt_pk_bf16_f32 v115, v102, v103
    v_cvt_pk_bf16_f32 v116, v104, v105
    v_cvt_pk_bf16_f32 v117, v106, v107
    ds_write_b64 v14, v[112:113] offset:0
    ds_write_b64 v14, v[114:115] offset:4352
    ds_write_b64 v14, v[116:117] offset:8704
    ds_read_b128 v[32:35], v11 offset:13056
    ds_read_b128 v[36:39], v11 offset:13120
    ds_read_b128 v[40:43], v11 offset:13184
    ds_read_b128 v[44:47], v11 offset:13248
    ds_read_b128 v[48:51], v11 offset:17408
    ds_read_b128 v[52:55], v11 offset:17472
    ds_read_b128 v[56:59], v11 offset:17536
    ds_read_b128 v[60:63], v11 offset:17600
    ds_read_b128 v[64:67], v11 offset:21760
    ds_read_b128 v[68:71], v11 offset:21824
    ds_read_b128 v[72:75], v11 offset:21888
    ds_read_b128 v[76:79], v11 offset:21952
    s_waitcnt lgkmcnt(8)
    v_mfma_f32_16x16x32_bf16 v[96:99], v[16:19], v[32:35], 0
    v_mfma_f32_16x16x32_bf16 v[96:99], v[20:23], v[36:39], v[96:99]
    v_mfma_f32_16x16x32_bf16 v[96:99], v[24:27], v[40:43], v[96:99]
    v_mfma_f32_16x16x32_bf16 v[96:99], v[28:31], v[44:47], v[96:99]
    s_waitcnt lgkmcnt(4)
    v_mfma_f32_16x16x32_bf16 v[100:103], v[16:19], v[48:51], 0
    v_mfma_f32_16x16x32_bf16 v[100:103], v[20:23], v[52:55], v[100:103]
    v_mfma_f32_16x16x32_bf16 v[100:103], v[24:27], v[56:59], v[100:103]
    v_mfma_f32_16x16x32_bf16 v[100:103], v[28:31], v[60:63], v[100:103]
    s_waitcnt lgkmcnt(0)
    v_mfma_f32_16x16x32_bf16 v[104:107], v[16:19], v[64:67], 0
    v_mfma_f32_16x16x32_bf16 v[104:107], v[20:23], v[68:71], v[104:107]
    v_mfma_f32_16x16x32_bf16 v[104:107], v[24:27], v[72:75], v[104:107]
    v_mfma_f32_16x16x32_bf16 v[104:107], v[28:31], v[76:79], v[104:107]
    v_mul_f32 v112, s34, v96
    v_mul_f32 v113, s34, v97
    v_mul_f32 v114, s34, v98
    v_mul_f32 v115, s34, v99
    v_mul_f32 v116, s34, v100
    v_mul_f32 v117, s34, v101
    v_mul_f32 v118, s34, v102
    v_mul_f32 v119, s34, v103
    v_mul_f32 v120, s34, v104
    v_mul_f32 v121, s34, v105
    v_mul_f32 v122, s34, v106
    v_mul_f32 v123, s34, v107
    v_exp_f32 v112, v112
    v_exp_f32 v113, v113
    v_exp_f32 v114, v114
    v_exp_f32 v115, v115
    v_exp_f32 v116, v116
    v_exp_f32 v117, v117
    v_exp_f32 v118, v118
    v_exp_f32 v119, v119
    v_exp_f32 v120, v120
    v_exp_f32 v121, v121
    v_exp_f32 v122, v122
    v_exp_f32 v123, v123
    v_add_f32 v112, 1.0, v112
    v_add_f32 v113, 1.0, v113
    v_add_f32 v114, 1.0, v114
    v_add_f32 v115, 1.0, v115
    v_add_f32 v116, 1.0, v116
    v_add_f32 v117, 1.0, v117
    v_add_f32 v118, 1.0, v118
    v_add_f32 v119, 1.0, v119
    v_add_f32 v120, 1.0, v120
    v_add_f32 v121, 1.0, v121
    v_add_f32 v122, 1.0, v122
    v_add_f32 v123, 1.0, v123
    v_rcp_f32 v112, v112
    v_rcp_f32 v113, v113
    v_rcp_f32 v114, v114
    v_rcp_f32 v115, v115
    v_rcp_f32 v116, v116
    v_rcp_f32 v117, v117
    v_rcp_f32 v118, v118
    v_rcp_f32 v119, v119
    v_rcp_f32 v120, v120
    v_rcp_f32 v121, v121
    v_rcp_f32 v122, v122
    v_rcp_f32 v123, v123
    v_mul_f32 v96, v96, v112
    v_mul_f32 v97, v97, v113
    v_mul_f32 v98, v98, v114
    v_mul_f32 v99, v99, v115
    v_mul_f32 v100, v100, v116
    v_mul_f32 v101, v101, v117
    v_mul_f32 v102, v102, v118
    v_mul_f32 v103, v103, v119
    v_mul_f32 v104, v104, v120
    v_mul_f32 v105, v105, v121
    v_mul_f32 v106, v106, v122
    v_mul_f32 v107, v107, v123
    v_cvt_pk_bf16_f32 v112, v96, v97
    v_cvt_pk_bf16_f32 v113, v98, v99
    v_cvt_pk_bf16_f32 v114, v100, v101
    v_cvt_pk_bf16_f32 v115, v102, v103
    v_cvt_pk_bf16_f32 v116, v104, v105
    v_cvt_pk_bf16_f32 v117, v106, v107
    ds_write_b64 v14, v[112:113] offset:13056
    ds_write_b64 v14, v[114:115] offset:17408
    ds_write_b64 v14, v[116:117] offset:21760
    s_waitcnt lgkmcnt(0)
    s_barrier
    s_mul_i32 s30, s3, 1088
    s_add_u32 s30, s30, 94720
    v_add_u32 v13, s30, v12
    ds_read_b128 v[32:35], v13 offset:0
    ds_read_b128 v[36:39], v13 offset:17408
    ds_read_b128 v[40:43], v13 offset:34816
    s_lshl_b32 s30, s3, 2
    s_add_u32 s30, s30, s28
    s_lshl_b32 s30, s30, 8
    s_add_u32 s30, s30, 8388608
    s_waitcnt lgkmcnt(0)
    buffer_store_dwordx4 v[32:35], v6, s[24:27], s30 offen sc1
    s_add_u32 s30, s30, 16384
    buffer_store_dwordx4 v[36:39], v6, s[24:27], s30 offen sc1
    s_add_u32 s30, s30, 16384
    buffer_store_dwordx4 v[40:43], v6, s[24:27], s30 offen sc1
    s_add_u32 s30, s30, 16384
    s_endpgm
K1_PREP:
    s_sub_u32 s28, s2, 243
    s_lshl_b32 s28, s28, 4
    s_add_u32 s28, s28, s3
    s_cmp_ge_u32 s28, 104
    s_cbranch_scc1 K1_END
    s_and_b32 s29, s28, 7
    s_lshr_b32 s30, s28, 3
    s_waitcnt lgkmcnt(0)
    s_mov_b32 s24, s10
    s_and_b32 s25, s11, 0xffff
    s_mov_b32 s26, 20971520
    s_mov_b32 s27, 0x00020000
    s_cmp_ge_u32 s30, 12
    s_cbranch_scc1 K1_PREP_RBF
    s_mov_b32 s32, s42
    s_and_b32 s33, s43, 0xffff
    s_mov_b32 s34, 98304
    s_mov_b32 s35, 0x00020000
    s_and_b32 s31, s30, 3
    s_lshr_b32 s37, s30, 2
    s_lshl_b32 s37, s37, 8
    s_lshl_b32 s38, s29, 5
    s_add_u32 s37, s37, s38
    s_mul_i32 s38, s31, 24576
    s_add_u32 s37, s37, s38
    v_mul_u32_u24 v5, 6144, v4
    v_lshl_add_u32 v5, v3, 1, v5
    buffer_load_ushort v16, v5, s[32:35], s37 offen
    s_add_u32 s37, s37, 768
    buffer_load_ushort v17, v5, s[32:35], s37 offen
    s_add_u32 s37, s37, 768
    buffer_load_ushort v18, v5, s[32:35], s37 offen
    s_add_u32 s37, s37, 768
    buffer_load_ushort v19, v5, s[32:35], s37 offen
    s_add_u32 s37, s37, 768
    buffer_load_ushort v20, v5, s[32:35], s37 offen
    s_add_u32 s37, s37, 768
    buffer_load_ushort v21, v5, s[32:35], s37 offen
    s_add_u32 s37, s37, 768
    buffer_load_ushort v22, v5, s[32:35], s37 offen
    s_add_u32 s37, s37, 768
    buffer_load_ushort v23, v5, s[32:35], s37 offen
    s_lshl_b32 s38, s28, 10
    s_add_u32 s38, s38, 4194304
    s_waitcnt vmcnt(0)
    v_lshl_or_b32 v8, v17, 16, v16
    v_lshl_or_b32 v9, v19, 16, v18
    v_lshl_or_b32 v10, v21, 16, v20
    v_lshl_or_b32 v11, v23, 16, v22
    buffer_store_dwordx4 v[8:11], v12, s[24:27], s38 offen
    s_endpgm
    s_nop 0
K1_PREP_RBF:
    s_mov_b32 s32, s44
    s_and_b32 s33, s45, 0xffff
    s_mov_b32 s34, 3072
    s_mov_b32 s35, 0x00020000
    s_lshl_b32 s37, s29, 5
    v_lshlrev_b32 v5, 1, v3
    v_cmp_eq_u32 vcc, 0, v4
    v_add_u32 v6, 512, v5
    s_nop 0
    v_cndmask_b32 v6, v6, v5, vcc
    buffer_load_ushort v16, v6, s[32:35], s37 offen offset:0
    buffer_load_ushort v17, v6, s[32:35], s37 offen offset:768
    buffer_load_ushort v18, v6, s[32:35], s37 offen offset:1536
    buffer_load_ushort v19, v6, s[32:35], s37 offen offset:2304
    buffer_load_ushort v20, v5, s[32:35], s37 offen offset:256
    buffer_load_ushort v21, v5, s[32:35], s37 offen offset:1024
    buffer_load_ushort v22, v5, s[32:35], s37 offen offset:1792
    buffer_load_ushort v23, v5, s[32:35], s37 offen offset:2560
    s_lshl_b32 s38, s28, 10
    s_add_u32 s38, s38, 4194304
    s_waitcnt vmcnt(0)
    v_lshl_or_b32 v8, v17, 16, v16
    v_lshl_or_b32 v9, v19, 16, v18
    v_lshl_or_b32 v10, v21, 16, v20
    v_lshl_or_b32 v11, v23, 16, v22
    buffer_store_dwordx4 v[8:11], v12, s[24:27], s38 offen
    s_nop 1
K1_END:
    s_endpgm
.p2align 8
k2_kernel:
    s_cmp_ge_u32 s2, 256
    s_cbranch_scc1 K2_END
    s_load_dwordx2 s[72:73], s[0:1], 80
    s_load_dwordx4 s[60:63], s[0:1], 0
    s_load_dwordx2 s[64:65], s[0:1], 32
    s_load_dwordx4 s[68:71], s[0:1], 64
    v_lshrrev_b32 v1, 6, v0
    s_nop 0
    v_readfirstlane_b32 s3, v1
    v_and_b32 v1, 63, v0
    v_and_b32 v2, 15, v0
    v_bfe_u32 v3, v0, 4, 2
    v_lshrrev_b32 v64, 2, v0
    v_lshlrev_b32 v64, 14, v64
    v_and_b32 v65, 3, v0
    v_lshl_add_u32 v64, v65, 4, v64
    s_lshl_b32 s74, s2, 6
    v_lshlrev_b32 v10, 4, v1
    v_lshlrev_b32 v27, 3, v1
    s_lshl_b32 s78, s3, 10
    s_waitcnt lgkmcnt(0)
    s_mov_b32 s36, s72
    s_and_b32 s37, s73, 0xffff
    s_mov_b32 s38, 1835008
    s_mov_b32 s39, 0x00020000
    buffer_load_dwordx4 v[36:39], v64, s[36:39], s74 offen
    s_load_dwordx2 s[76:77], s[64:65], 0
    s_mov_b32 s16, s72
    s_and_b32 s17, s73, 0xffff
    s_mov_b32 s18, 20971520
    s_mov_b32 s19, 0x00020000
    s_add_u32 s79, s78, 4194304
    buffer_load_dwordx4 a[0:3], v10, s[16:19], s79 offen
    s_add_u32 s79, s78, 4202496
    buffer_load_dwordx4 a[4:7], v10, s[16:19], s79 offen
    s_add_u32 s79, s78, 4210688
    buffer_load_dwordx4 a[8:11], v10, s[16:19], s79 offen
    s_mov_b32 s8, s60
    s_and_b32 s9, s61, 0xffff
    s_mov_b32 s10, 25600000
    s_mov_b32 s11, 0x00020000
    s_mov_b32 s24, s60
    s_and_b32 s25, s61, 0xffff
    s_mov_b32 s26, 25600000
    s_mov_b32 s27, 0x00020000
    s_mov_b32 s20, s62
    s_and_b32 s21, s63, 0xffff
    s_mov_b32 s22, 150000
    s_mov_b32 s23, 0x00020000
    s_mov_b32 s12, s68
    s_and_b32 s13, s69, 0xffff
    s_mov_b32 s14, 25600000
    s_mov_b32 s15, 0x00020000
    s_mov_b32 s96, s70
    s_and_b32 s97, s71, 0xffff
    s_mov_b32 s98, 256
    s_mov_b32 s99, 0x00020000
    s_add_u32 s4, s72, 8388608
    s_addc_u32 s5, s73, 0
    s_and_b32 s5, s5, 0xffff
    s_mov_b32 s6, 6400000
    s_mov_b32 s7, 0x00020000
    s_mul_i32 s28, s2, 98
    s_sub_u32 s29, 25000, s28
    s_min_u32 s29, s29, 98
    s_add_u32 s26, s28, s29
    s_lshl_b32 s26, s26, 10
    s_mov_b32 s88, 0xffff0000
    s_mov_b32 s89, 1073741824
    v_mov_b32 v23, s89
    s_mov_b32 s90, 0xbfb8aa3b
    s_mov_b32 s91, 0
    v_mov_b32 v84, 0
    v_mov_b32 v85, 0
    v_mov_b32 v86, 0
    v_mov_b32 v87, 0
    v_lshlrev_b32 v82, 4, v0
    v_add_u32 v82, 140672, v82
    ds_write_b128 v82, v[84:87]
    ds_write_b128 v82, v[84:87] offset:8192
    v_cmp_gt_u32 vcc, 64, v0
    s_nop 0
    s_and_saveexec_b64 s[74:75], vcc
    s_nop 2
    s_cbranch_execz K2_I1
    ds_write_b128 v82, v[84:87] offset:16384
    v_add_u32 v83, 161552, v27
    ds_write_b64 v83, v[84:85]
    v_mov_b32 v83, 162640
    ds_write_b64 v83, v[84:85]
    s_nop 0
K2_I1:
    s_mov_b64 exec, -1
    s_add_u32 s79, s78, 4218880
    buffer_load_dwordx4 a[12:15], v10, s[16:19], s79 offen
    s_add_u32 s79, s78, 4227072
    buffer_load_dwordx4 a[16:19], v10, s[16:19], s79 offen
    v_subrev_u32 v81, 64, v0
    v_cmp_gt_u32 vcc, 81, v81
    s_nop 0
    s_and_saveexec_b64 s[74:75], vcc
    s_nop 2
    s_cbranch_execz K2_I2
    v_mul_u32_u24 v82, 57, v81
    v_lshrrev_b32 v82, 9, v82
    v_mul_u32_u24 v83, 9, v82
    v_sub_u32 v83, v81, v83
    v_mov_b32 v89, 1
    v_lshlrev_b32 v88, v83, v89
    v_lshlrev_b32 v89, v82, v89
    v_sub_u32 v88, v88, v89
    v_max_i32 v88, 0, v88
    s_mov_b32 s66, 0x3f80
    s_mov_b32 s67, 0x3f800000
    v_bfe_i32 v89, v88, 0, 1
    v_bfe_i32 v90, v88, 1, 1
    v_and_b32 v89, s66, v89
    v_and_or_b32 v92, v90, s67, v89
    v_bfe_i32 v89, v88, 2, 1
    v_bfe_i32 v90, v88, 3, 1
    v_and_b32 v89, s66, v89
    v_and_or_b32 v93, v90, s67, v89
    v_bfe_i32 v89, v88, 4, 1
    v_bfe_i32 v90, v88, 5, 1
    v_and_b32 v89, s66, v89
    v_and_or_b32 v94, v90, s67, v89
    v_bfe_i32 v89, v88, 6, 1
    v_bfe_i32 v90, v88, 7, 1
    v_and_b32 v89, s66, v89
    v_and_or_b32 v95, v90, s67, v89
    v_lshlrev_b32 v82, 4, v81
    v_add_u32 v82, 160256, v82
    ds_write_b128 v82, v[92:95]
    s_nop 0
K2_I2:
    s_mov_b64 exec, -1
    v_lshrrev_b32 v80, 2, v2
    v_and_b32 v81, 3, v2
    v_lshl_add_u32 v82, v80, 3, v81
    v_xor_b32 v83, v3, v81
    v_lshlrev_b32 v83, 4, v83
    v_lshl_add_u32 v83, v81, 8, v83
    v_mul_u32_u24 v84, 8256, v80
    v_add_u32 v4, v83, v84
    v_lshrrev_b32 v84, 1, v3
    s_lshl_b32 s74, s3, 1
    v_add_u32 v84, s74, v84
    v_and_b32 v85, 1, v3
    v_lshlrev_b32 v85, 3, v85
    v_lshl_add_u32 v9, v84, 4, v85
    v_and_b32 v84, 1, v80
    v_lshlrev_b32 v84, 1, v84
    v_lshrrev_b32 v85, 1, v80
    v_lshl_add_u32 v84, v85, 3, v84
    v_lshrrev_b32 v85, 1, v81
    v_add_u32 v85, s74, v85
    v_xor_b32 v84, v84, v85
    v_lshlrev_b32 v84, 4, v84
    v_and_b32 v85, 1, v81
    v_lshl_add_u32 v84, v85, 3, v84
    v_lshl_add_u32 v84, v80, 8, v84
    v_mul_u32_u24 v85, 8256, v3
    v_add3_u32 v7, v84, v85, 0
    v_add_u32 v7, 1024, v7
    s_add_u32 s79, s78, 4235264
    buffer_load_dwordx4 a[20:23], v10, s[16:19], s79 offen
    s_add_u32 s79, s78, 4243456
    buffer_load_dwordx4 a[24:27], v10, s[16:19], s79 offen
    v_lshlrev_b32 v12, 3, v3
    v_lshl_add_u32 v8, v82, 5, v12
    v_add_u32 v8, 140672, v8
    v_xor_b32 v84, v2, v3
    v_lshlrev_b32 v16, 4, v84
    v_and_b32 v84, 1, v3
    v_lshlrev_b32 v84, 1, v84
    v_lshrrev_b32 v85, 1, v3
    v_lshl_add_u32 v84, v85, 3, v84
    v_xor_b32 v84, v84, v2
    v_lshlrev_b32 v84, 4, v84
    v_add_u32 v17, 256, v84
    v_lshlrev_b32 v11, 2, v2
    v_add_u32 v11, 162064, v11
    s_lshl_b32 s74, s3, 2
    v_add_u32 v14, s74, v3
    v_lshlrev_b32 v13, 2, v14
    v_add_u32 v13, 158080, v13
    s_add_u32 s79, s78, 4251648
    buffer_load_dwordx4 a[28:31], v10, s[16:19], s79 offen
    s_waitcnt lgkmcnt(0)
    s_lshl_b32 s84, s76, 16
    s_and_b32 s85, s76, s88
    s_lshl_b32 s86, s77, 16
    s_and_b32 s87, s77, s88
    s_barrier
    s_waitcnt vmcnt(8)
    v_and_b32 v65, 3, v0
    v_mul_u32_u24 v66, 7, v65
    v_add_u32 v66, 1, v66
    v_lshrrev_b32 v66, 1, v66
    v_subrev_u32 v66, 1, v66
    v_and_b32 v67, 1, v0
    v_cmp_eq_u32 s[94:95], 1, v67
    v_mov_b32_dpp v82, v36 quad_perm:[0,0,0,0] row_mask:0xf bank_mask:0xf
    v_cmp_lt_u32 s[70:71], 14, v82
    v_min_u32 v82, 14, v82
    v_sub_u32 v80, v82, v66
    s_nop 2
K2_PASS:
    s_lshl_b32 s52, s28, 10
    s_add_u32 s54, s52, s78
    s_mul_i32 s53, s3, 1040
    v_mov_b32 v67, 1
    s_cmp_eq_u64 s[70:71], 0
    s_nop 0
    s_cbranch_scc1 K2_NOFLAG
    v_mov_b32 v83, 162640
    ds_write_b32 v83, v67
    s_nop 0
K2_NOFLAG:
    s_lshl_b32 s74, s28, 2
    s_sub_u32 s74, 161552, s74
    v_cmp_lt_i32 s[40:41], 0, v80
    v_lshrrev_b32 v84, 16, v36
    v_lshl_add_u32 v84, v84, 2, s74
    v_cmp_lt_i32 s[42:43], 1, v80
    v_lshrrev_b32 v85, 16, v37
    v_lshl_add_u32 v85, v85, 2, s74
    v_cmp_lt_i32 s[44:45], 2, v80
    v_lshrrev_b32 v86, 16, v38
    v_lshl_add_u32 v86, v86, 2, s74
    v_cmp_lt_i32 s[46:47], 3, v80
    v_lshrrev_b32 v87, 16, v39
    v_lshl_add_u32 v87, v87, 2, s74
    s_and_b64 s[40:41], s[40:41], s[94:95]
    s_mov_b64 exec, s[40:41]
    ds_add_rtn_u32 v92, v84, v67
    s_mov_b64 exec, s[42:43]
    ds_add_rtn_u32 v93, v85, v67
    s_mov_b64 exec, s[44:45]
    ds_add_rtn_u32 v94, v86, v67
    s_mov_b64 exec, s[46:47]
    ds_add_rtn_u32 v95, v87, v67
    s_mov_b64 exec, -1
    v_add_u32 v100, 161552, v27
    v_mov_b32 v101, 162640
    s_add_u32 s79, s54, 0
    s_add_u32 m0, s53, 0
    s_nop 0
    buffer_load_dwordx4 v10, s[24:27], s79 offen nt lds
    s_add_u32 s79, s54, 8192
    s_add_u32 m0, s53, 8320
    s_nop 0
    buffer_load_dwordx4 v10, s[24:27], s79 offen nt lds
    s_waitcnt lgkmcnt(0)
    s_barrier
    ds_read_b64 v[102:103], v100
    ds_read_b32 v101, v101
    v_mov_b32 v15, 0
    s_mov_b32 s32, 0
    s_mov_b32 s33, 0
    s_mov_b32 s34, 0
    s_mov_b32 s35, 0
    s_mov_b32 s31, 0
    v_lshlrev_b32 v92, 2, v92
    v_add_u32 v92, 158080, v92
    v_lshlrev_b32 v93, 2, v93
    v_add_u32 v93, 158080, v93
    v_lshlrev_b32 v94, 2, v94
    v_add_u32 v94, 158080, v94
    v_lshlrev_b32 v95, 2, v95
    v_add_u32 v95, 158080, v95
    s_waitcnt lgkmcnt(0)
    v_add_u32 v104, v102, v103
    v_mov_b32 v105, v104
    s_nop 1
    v_add_u32_dpp v105, v105, v105 row_shr:1 row_mask:0xf bank_mask:0xf
    s_nop 1
    v_add_u32_dpp v105, v105, v105 row_shr:2 row_mask:0xf bank_mask:0xf
    s_nop 1
    v_add_u32_dpp v105, v105, v105 row_shr:4 row_mask:0xf bank_mask:0xf
    s_nop 1
    v_add_u32_dpp v105, v105, v105 row_shr:8 row_mask:0xf bank_mask:0xf
    s_nop 1
    v_add_u32_dpp v105, v105, v105 row_bcast:15 row_mask:0xa bank_mask:0xf
    s_nop 1
    v_add_u32_dpp v105, v105, v105 row_bcast:31 row_mask:0xc bank_mask:0xf
    v_sub_u32 v20, v105, v104
    v_add_u32 v21, v20, v102
    ds_write_b64 v100, v[20:21] offset:512
    v_readlane_b32 s30, v105, 63
    v_readfirstlane_b32 s74, v101
    s_cmp_gt_u32 s30, 512
    s_cselect_b32 s75, 1, 0
    s_or_b32 s74, s74, s75
    s_cmp_lg_u32 s74, 0
    s_nop 0
    s_cbranch_scc1 K2_SLOW
    s_mov_b64 exec, s[40:41]
    ds_read_b32 v84, v84 offset:512
    s_mov_b64 exec, s[42:43]
    ds_read_b32 v85, v85 offset:512
    s_mov_b64 exec, s[44:45]
    ds_read_b32 v86, v86 offset:512
    s_mov_b64 exec, s[46:47]
    ds_read_b32 v87, v87 offset:512
    s_mov_b64 exec, -1
    s_add_u32 s79, s78, 4259840
    buffer_load_dwordx4 a[32:35], v10, s[16:19], s79 offen
    s_waitcnt lgkmcnt(0)
    v_lshl_add_u32 v84, v84, 2, v92
    v_lshl_add_u32 v85, v85, 2, v93
    v_lshl_add_u32 v86, v86, 2, v94
    v_lshl_add_u32 v87, v87, 2, v95
    s_mov_b64 exec, s[40:41]
    ds_write_b32 v84, v36
    s_mov_b64 exec, s[42:43]
    ds_write_b32 v85, v37
    s_mov_b64 exec, s[44:45]
    ds_write_b32 v86, v38
    s_mov_b64 exec, s[46:47]
    ds_write_b32 v87, v39
    s_mov_b64 exec, -1
    s_add_u32 s79, s78, 4268032
    buffer_load_dwordx4 a[36:39], v10, s[16:19], s79 offen
    s_add_u32 s79, s78, 4276224
    buffer_load_dwordx4 a[40:43], v10, s[16:19], s79 offen
    s_cmp_ge_u32 s32, s29
    s_cbranch_scc1 K2_END
    s_add_u32 s64, s34, 32
    v_cmp_gt_u32 s[60:61], s64, v20
    v_cmp_gt_u32 s[62:63], s64, v21
    s_bcnt1_i32_b64 s66, s[60:61]
    s_bcnt1_i32_b64 s67, s[62:63]
    s_add_u32 s66, s66, s67
    s_add_u32 s67, s32, 13
    s_min_u32 s66, s66, s67
    s_min_u32 s67, s66, s29
    s_lshr_b32 s66, s67, 1
    v_readlane_b32 s35, v20, s66
    v_readlane_b32 s68, v21, s66
    s_bitcmp1_b32 s67, 0
    s_cselect_b32 s35, s68, s35
    s_sub_u32 s60, s67, s32
    s_cmp_gt_u32 s35, s64
    s_cselect_b32 s61, 1, 0
    s_sub_u32 s62, s60, s61
    s_cmp_eq_u32 s62, 0
    s_cselect_b32 s63, 1, s33
    s_cmp_lg_u32 s63, 0
    s_cbranch_scc1 W_HUB_1
    s_min_u32 s64, s64, s35
    s_lshl_b32 s61, s61, 4
    s_or_b32 s60, s60, s61
    s_or_b32 s60, s60, 0xe0
W_BACK_2:
    s_lshl_b32 s60, s60, 7
    s_or_b32 s60, s60, s32
    s_sub_u32 s66, s64, s34
    s_lshl_b32 s66, s66, 10
    s_or_b32 s66, s66, s34
    s_pack_ll_b32_b16 s65, s66, s60
    s_mov_b32 s34, s64
    s_add_u32 s32, s32, s62
    s_mov_b32 m0, s31
    s_add_u32 s31, s31, 1
    v_writelane_b32 v15, s65, m0
    v_lshlrev_b32 v64, 2, v0
    v_add_u32 v64, 158080, v64
    s_lshl_b32 s52, s28, 10
    s_lshl_b32 s51, s3, 12
    s_lshr_b32 s74, s3, 1
    s_lshl_b32 s74, s74, 6
    s_add_u32 s51, s51, s74
    s_movk_i32 s55, 1040
    s_mov_b32 s49, s3
    s_mul_i32 s53, s3, 1040
    s_mov_b32 s56, 0
    s_mov_b32 s42, 41600
    s_waitcnt lgkmcnt(0)
    s_barrier
    s_cmp_lg_u32 s3, 7
    s_cbranch_scc1 K2_NOWALK
    s_setprio 3
K2_WALK:
    s_cmp_ge_u32 s32, s29
    s_cbranch_scc1 K2_WALKED
    s_add_u32 s64, s34, 32
    v_cmp_gt_u32 s[60:61], s64, v20
    v_cmp_gt_u32 s[62:63], s64, v21
    s_bcnt1_i32_b64 s66, s[60:61]
    s_bcnt1_i32_b64 s67, s[62:63]
    s_add_u32 s66, s66, s67
    s_add_u32 s67, s32, 13
    s_min_u32 s66, s66, s67
    s_min_u32 s67, s66, s29
    s_lshr_b32 s66, s67, 1
    v_readlane_b32 s35, v20, s66
    v_readlane_b32 s68, v21, s66
    s_bitcmp1_b32 s67, 0
    s_cselect_b32 s35, s68, s35
    s_sub_u32 s60, s67, s32
    s_cmp_gt_u32 s35, s64
    s_cselect_b32 s61, 1, 0
    s_sub_u32 s62, s60, s61
    s_cmp_eq_u32 s62, 0
    s_cselect_b32 s63, 1, s33
    s_cmp_lg_u32 s63, 0
    s_cbranch_scc1 W_HUB_3
    s_min_u32 s64, s64, s35
    s_lshl_b32 s61, s61, 4
    s_or_b32 s60, s60, s61
    s_or_b32 s60, s60, 0xe0
W_BACK_4:
    s_lshl_b32 s60, s60, 7
    s_or_b32 s60, s60, s32
    s_sub_u32 s66, s64, s34
    s_lshl_b32 s66, s66, 10
    s_or_b32 s66, s66, s34
    s_pack_ll_b32_b16 s65, s66, s60
    s_mov_b32 s34, s64
    s_add_u32 s32, s32, s62
    s_mov_b32 m0, s31
    s_add_u32 s31, s31, 1
    v_writelane_b32 v15, s65, m0
    s_nop 1
    s_branch K2_WALK
K2_WALKED:
    v_lshlrev_b32 v67, 2, v1
    v_add_u32 v67, 162672, v67
    ds_write_b32 v67, v15
    v_readlane_b32 s65, v15, 0
    s_waitcnt lgkmcnt(0)
    s_nop 3
K2_NOWALK:
    s_and_b32 s66, s65, 0x3ff
    s_lshl_b32 s66, s66, 2
    v_add_u32 v31, s66, v13
    ds_read_b32 v31, v31
    s_bfe_u32 s64, s65, 0x6000a
    ds_read_b32 v64, v64
    v_cmp_gt_u32 s[94:95], s30, v0
    s_waitcnt lgkmcnt(0)
    v_and_b32 v65, 0xffff, v64
    v_lshrrev_b32 v66, 16, v64
    s_cmp_eq_u64 s[94:95], 0
    s_nop 0
    s_cbranch_scc1 K2_NOPOS
    v_mul_u32_u24 v67, 6, v65
    v_mul_u32_u24 v68, 6, v66
    v_and_b32 v67, -4, v67
    v_and_b32 v68, -4, v68
    v_cndmask_b32 v67, v23, v67, s[94:95]
    v_cndmask_b32 v68, v23, v68, s[94:95]
    buffer_load_dwordx2 v[70:71], v67, s[20:23], 0 offen
    buffer_load_dwordx2 v[72:73], v68, s[20:23], 0 offen
K2_NOPOS:
    v_cmp_gt_u32 vcc, s64, v14
    v_and_b32 v31, 0xffff, v31
    v_lshl_add_u32 v5, v31, 8, v16
    v_lshl_add_u32 v6, v31, 10, v17
    v_cndmask_b32 v5, v23, v5, vcc
    v_cndmask_b32 v6, v23, v6, vcc
    s_add_u32 s69, s42, s51
    s_mov_b32 m0, s69
    s_nop 0
    buffer_load_dwordx4 v5, s[4:7], 0 offen lds
    s_add_u32 m0, s69, 1024
    s_nop 0
    buffer_load_dwordx4 v6, s[8:11], 0 offen offset:0 lds
    s_add_u32 m0, s69, 1792
    s_nop 0
    buffer_load_dwordx4 v6, s[8:11], 0 offen offset:256 lds
    s_add_u32 m0, s69, 2560
    s_nop 0
    buffer_load_dwordx4 v6, s[8:11], 0 offen offset:512 lds
    s_add_u32 s79, s78, 4284416
    buffer_load_dwordx4 a[44:47], v10, s[16:19], s79 offen
    s_add_u32 s79, s78, 4292608
    buffer_load_dwordx4 v[164:167], v10, s[16:19], s79 offen
    v_and_b32 v65, 1, v65
    v_lshlrev_b32 v65, 4, v65
    v_and_b32 v66, 1, v66
    v_lshlrev_b32 v66, 4, v66
    s_cmp_eq_u64 s[94:95], 0
    s_nop 0
    s_cbranch_scc1 K2_NOPAY
    s_waitcnt vmcnt(6)
    v_alignbit_b32 v70, v71, v70, v65
    v_lshrrev_b32 v71, v65, v71
    v_alignbit_b32 v72, v73, v72, v66
    v_lshrrev_b32 v73, v66, v73
    v_lshlrev_b32 v74, 16, v70
    v_lshlrev_b32 v77, 16, v72
    v_sub_f32 v74, v74, v77
    v_and_b32 v75, s88, v70
    v_and_b32 v77, s88, v72
    v_sub_f32 v75, v75, v77
    v_lshlrev_b32 v76, 16, v71
    v_lshlrev_b32 v77, 16, v73
    v_sub_f32 v76, v76, v77
    v_cvt_pk_bf16_f32 v77, v74, v75
    v_lshlrev_b32 v74, 16, v77
    v_and_b32 v75, s88, v77
    v_cvt_pk_bf16_f32 v76, v76, v76
    v_lshlrev_b32 v76, 16, v76
    v_mul_f32 v78, v74, v74
    v_mul_f32 v79, v75, v75
    v_mul_f32 v80, v76, v76
    v_cvt_pk_bf16_f32 v77, v78, v79
    v_lshlrev_b32 v78, 16, v77
    v_and_b32 v79, s88, v77
    v_cvt_pk_bf16_f32 v80, v80, v80
    v_lshlrev_b32 v80, 16, v80
    v_add_f32 v78, v78, v79
    v_add_f32 v78, v78, v80
    v_cvt_pk_bf16_f32 v78, v78, v78
    v_lshlrev_b32 v78, 16, v78
    v_add_f32 v78, 0x322bcc77, v78
    v_cvt_pk_bf16_f32 v78, v78, v78
    v_lshlrev_b32 v78, 16, v78
    v_sqrt_f32 v78, v78
    s_nop 0
    v_cvt_pk_bf16_f32 v78, v78, v78
    v_lshlrev_b32 v78, 16, v78
    v_rcp_f32 v79, v78
    s_nop 0
    v_mul_f32 v74, v74, v79
    v_mul_f32 v75, v75, v79
    v_mul_f32 v76, v76, v79
    v_cvt_pk_bf16_f32 v77, v74, v75
    v_lshlrev_b32 v74, 16, v77
    v_and_b32 v75, s88, v77
    v_cvt_pk_bf16_f32 v76, v76, v76
    v_lshlrev_b32 v76, 16, v76
    v_mul_f32 v80, s84, v78
    v_mul_f32 v81, s85, v78
    v_mul_f32 v82, s86, v78
    v_mul_f32 v83, s87, v78
    v_cvt_pk_bf16_f32 v77, v80, v81
    v_lshlrev_b32 v80, 16, v77
    v_and_b32 v81, s88, v77
    v_cvt_pk_bf16_f32 v77, v82, v83
    v_lshlrev_b32 v82, 16, v77
    v_and_b32 v83, s88, v77
    v_mul_f32 v80, 0.15915494, v80
    v_fract_f32 v80, v80
    v_sin_f32 v80, v80
    v_mul_f32 v81, 0.15915494, v81
    v_fract_f32 v81, v81
    v_sin_f32 v81, v81
    v_mul_f32 v82, 0.15915494, v82
    v_fract_f32 v82, v82
    v_sin_f32 v82, v82
    v_mul_f32 v83, 0.15915494, v83
    v_fract_f32 v83, v83
    v_sin_f32 v83, v83
    v_cvt_pk_bf16_f32 v77, v80, v81
    v_lshlrev_b32 v80, 16, v77
    v_and_b32 v81, s88, v77
    v_cvt_pk_bf16_f32 v77, v82, v83
    v_lshlrev_b32 v82, 16, v77
    v_and_b32 v83, s88, v77
    v_mul_f32 v80, v80, v79
    v_mul_f32 v81, v81, v79
    v_mul_f32 v82, v82, v79
    v_mul_f32 v83, v83, v79
    v_cvt_pk_bf16_f32 v77, v80, v81
    v_lshlrev_b32 v80, 16, v77
    v_and_b32 v81, s88, v77
    v_cvt_pk_bf16_f32 v77, v82, v83
    v_lshlrev_b32 v82, 16, v77
    v_and_b32 v83, s88, v77
    v_mul_f32 v84, 0x40490fdb, v78
    v_cvt_pk_bf16_f32 v84, v84, v84
    v_lshlrev_b32 v84, 16, v84
    v_mul_f32 v84, 0x3e4ccccd, v84
    v_cvt_pk_bf16_f32 v84, v84, v84
    v_lshlrev_b32 v84, 16, v84
    v_mul_f32 v84, 0.15915494, v84
    v_fract_f32 v84, v84
    v_cos_f32 v84, v84
    s_nop 0
    v_cvt_pk_bf16_f32 v84, v84, v84
    v_lshlrev_b32 v84, 16, v84
    v_add_f32 v84, 1.0, v84
    v_cvt_pk_bf16_f32 v84, v84, v84
    v_lshlrev_b32 v84, 16, v84
    v_mul_f32 v84, 0.5, v84
    v_mul_f32 v85, 0, v78
    v_cmp_gt_f32 vcc, 0x40a00000, v78
    s_nop 1
    v_cndmask_b32 v84, v85, v84, vcc
    v_mul_f32 v80, v80, v84
    v_mul_f32 v81, v81, v84
    v_mul_f32 v82, v82, v84
    v_mul_f32 v83, v83, v84
    v_cvt_pk_bf16_f32 v88, v80, v81
    v_cvt_pk_bf16_f32 v89, v82, v83
    v_mul_f32 v96, v80, v74
    v_mul_f32 v97, v81, v74
    v_mul_f32 v98, v82, v74
    v_mul_f32 v99, v83, v74
    v_cvt_pk_bf16_f32 v90, v96, v97
    v_cvt_pk_bf16_f32 v91, v98, v99
    v_mul_f32 v96, v80, v75
    v_mul_f32 v97, v81, v75
    v_mul_f32 v98, v82, v75
    v_mul_f32 v99, v83, v75
    v_cvt_pk_bf16_f32 v92, v96, v97
    v_cvt_pk_bf16_f32 v93, v98, v99
    v_mul_f32 v96, v80, v76
    v_mul_f32 v97, v81, v76
    v_mul_f32 v98, v82, v76
    v_mul_f32 v99, v83, v76
    v_cvt_pk_bf16_f32 v94, v96, v97
    v_cvt_pk_bf16_f32 v95, v98, v99
    v_lshlrev_b32 v64, 5, v0
    v_add_u32 v64, 140672, v64
    s_mov_b64 exec, s[94:95]
    ds_write_b128 v64, v[88:91]
    ds_write_b128 v64, v[92:95] offset:16
    s_mov_b64 exec, -1
K2_NOPAY:
    s_add_u32 s79, s54, 16384
    s_add_u32 m0, s53, 16640
    s_nop 0
    buffer_load_dwordx4 v10, s[24:27], s79 offen nt lds
    s_add_u32 s79, s54, 24576
    s_add_u32 m0, s53, 24960
    s_nop 0
    buffer_load_dwordx4 v10, s[24:27], s79 offen nt lds
    s_add_u32 s79, s54, 32768
    s_add_u32 m0, s53, 33280
    s_nop 0
    buffer_load_dwordx4 v10, s[24:27], s79 offen nt lds
    s_waitcnt lgkmcnt(0)
    s_barrier
    s_setprio 0
    v_lshlrev_b32 v67, 2, v1
    v_add_u32 v67, 162672, v67
    ds_read_b32 v15, v67
    s_waitcnt lgkmcnt(0)
    v_readlane_b32 s65, v15, 1
    s_nop 0
    s_and_b32 s66, s65, 0x3ff
    s_lshl_b32 s66, s66, 2
    v_add_u32 v31, s66, v13
    ds_read_b32 v31, v31
    s_bfe_u32 s64, s65, 0x6000a
    s_mov_b32 s42, 74624
    s_waitcnt lgkmcnt(0)
    v_cmp_gt_u32 vcc, s64, v14
    v_and_b32 v31, 0xffff, v31
    v_lshl_add_u32 v5, v31, 8, v16
    v_lshl_add_u32 v6, v31, 10, v17
    v_cndmask_b32 v5, v23, v5, vcc
    v_cndmask_b32 v6, v23, v6, vcc
    s_add_u32 s69, s42, s51
    s_mov_b32 m0, s69
    s_nop 0
    buffer_load_dwordx4 v5, s[4:7], 0 offen lds
    s_add_u32 m0, s69, 1024
    s_nop 0
    buffer_load_dwordx4 v6, s[8:11], 0 offen offset:0 lds
    s_add_u32 m0, s69, 1792
    s_nop 0
    buffer_load_dwordx4 v6, s[8:11], 0 offen offset:256 lds
    s_add_u32 m0, s69, 2560
    s_nop 0
    buffer_load_dwordx4 v6, s[8:11], 0 offen offset:512 lds
    s_mov_b32 s40, -1
    s_mov_b32 s41, 107648
    s_mov_b32 s44, 0
    s_mov_b32 s45, 0
    s_mov_b32 s46, 0
    s_mov_b32 s59, 0
    s_mov_b32 s57, 0
    s_bitcmp1_b32 s46, 1
    s_cselect_b32 s66, s45, 0
    s_sub_u32 s67, s66, s57
    s_add_u32 s56, s44, s67
    v_cmp_gt_u32 s[76:77], s66, v2
    s_add_u32 s40, s40, 1
    s_add_u32 s59, s59, s67
    v_readlane_b32 s65, v15, s40
    s_add_u32 s61, s41, s51
    s_add_u32 s41, s41, 33024
    s_cmp_eq_u32 s41, 140672
    s_cselect_b32 s41, 41600, s41
    s_and_b32 s43, s65, 0x3ff
    v_add_u32 v24, s41, v4
    s_bfe_u32 s44, s65, 0x70010
    s_bfe_u32 s45, s65, 0x40017
    s_bfe_u32 s57, s65, 0x1001b
    v_add_u32 v25, s41, v7
    s_lshr_b32 s62, s65, 28
    s_lshl_b32 s66, s44, 2
    v_add_u32 v18, s66, v11
    s_lshl_b32 s66, s43, 5
    s_cmp_ge_u32 s59, 40
    v_add_u32 v19, s66, v8
    s_cselect_b32 s66, 40, 0
    s_sub_u32 s59, s59, s66
    v_add_u32 v27, s59, v2
    v_subrev_u32 v34, 40, v27
    v_min_u32 v27, v27, v34
    v_mad_u32_u24 v27, v27, s55, v9
    s_and_b32 s49, s3, 3
    s_mul_i32 s53, s49, 1040
    s_lshl_b32 s54, s49, 10
    s_add_u32 s54, s54, s52
    v_add_u32 v32, s53, v10
    s_add_u32 s66, s53, 4160
    s_cmp_ge_u32 s66, 41600
    s_cselect_b32 s68, 41600, 0
    s_sub_u32 s71, s66, s68
    v_add_u32 v33, s71, v10
    s_add_u32 s66, s71, 4160
    s_cmp_ge_u32 s66, 41600
    s_cselect_b32 s68, 41600, 0
    s_sub_u32 s72, s66, s68
    v_add_u32 v34, s72, v10
    s_add_u32 s66, s72, 4160
    s_cmp_ge_u32 s66, 41600
    s_cselect_b32 s68, 41600, 0
    s_sub_u32 s73, s66, s68
    v_add_u32 v35, s73, v10
    s_add_u32 s66, s73, 4160
    s_cmp_ge_u32 s66, 41600
    s_cselect_b32 s68, 41600, 0
    s_sub_u32 s74, s66, s68
    s_mov_b32 s40, -1
    s_add_u32 s66, s40, 3
    v_readlane_b32 s65, v15, s66
    s_nop 0
    s_and_b32 s66, s65, 0x3ff
    s_lshl_b32 s66, s66, 2
    v_add_u32 v31, s66, v13
    ds_read2_b32 v[190:191], v31 offset0:16 offset1:0
    s_bfe_u32 s64, s65, 0x6000a
    s_sub_i32 s63, s64, 16
    s_mov_b32 s40, 0
    ds_read_b64 v[156:157], v19
    ds_read_b64 v[158:159], v19 offset:128
    ds_read2_b32 v[28:29], v18 offset0:0 offset1:1
    s_waitcnt lgkmcnt(0)
    v_cmp_gt_u32 vcc, s64, v14
    v_cmp_gt_i32 s[66:67], s63, v14
    v_and_b32 v190, 0xffff, v190
    v_and_b32 v191, 0xffff, v191
    v_lshl_add_u32 v5, v191, 8, v16
    v_lshl_add_u32 v6, v191, 10, v17
    v_lshl_add_u32 v188, v190, 8, v16
    v_lshl_add_u32 v189, v190, 10, v17
    v_cndmask_b32 v5, v23, v5, vcc
    v_cndmask_b32 v6, v23, v6, vcc
    v_cndmask_b32 v188, v23, v188, s[66:67]
    v_cndmask_b32 v189, v23, v189, s[66:67]
    v_add_u32 v30, s43, v12
    v_sub_u32 v28, v28, v30
    v_sub_u32 v29, v29, v30
    v_med3_i32 v28, v28, 0, 8
    v_med3_i32 v29, v29, 0, 8
    v_mad_u32_u24 v28, v28, 9, v29
    v_lshlrev_b32 v28, 4, v28
    v_add_u32 v28, 160256, v28
    ds_read_b128 v[160:163], v28
    s_waitcnt vmcnt(7)
    v_cmp_eq_u32 vcc, 0, v3
    s_nop 1
    v_cndmask_b32 v168, 0, v164, vcc
    v_cndmask_b32 v169, 0, v165, vcc
    v_accvgpr_write_b32 a48, v168
    v_accvgpr_write_b32 a49, v169
    v_cmp_eq_u32 vcc, 0, v3
    s_nop 1
    v_cndmask_b32 v168, 0, v166, vcc
    v_cndmask_b32 v169, 0, v167, vcc
    v_accvgpr_write_b32 a50, v168
    v_accvgpr_write_b32 a51, v169
    v_cmp_eq_u32 vcc, 1, v3
    s_nop 1
    v_cndmask_b32 v168, 0, v164, vcc
    v_cndmask_b32 v169, 0, v165, vcc
    v_accvgpr_write_b32 a52, v168
    v_accvgpr_write_b32 a53, v169
    v_cmp_eq_u32 vcc, 2, v3
    s_nop 1
    v_cndmask_b32 v168, 0, v164, vcc
    v_cndmask_b32 v169, 0, v165, vcc
    v_accvgpr_write_b32 a54, v168
    v_accvgpr_write_b32 a55, v169
    v_cmp_eq_u32 vcc, 3, v3
    s_nop 1
    v_cndmask_b32 v168, 0, v164, vcc
    v_cndmask_b32 v169, 0, v165, vcc
    v_accvgpr_write_b32 a56, v168
    v_accvgpr_write_b32 a57, v169
    s_cmp_ge_u32 s3, 4
    s_nop 0
    s_cbranch_scc1 K2_LOOP1
    v_mfma_f32_16x16x16_bf16 v[92:95], v[156:157], a[48:49], 0
    v_mfma_f32_16x16x16_bf16 v[96:99], v[158:159], a[48:49], 0
    v_mfma_f32_16x16x16_bf16 v[100:103], v[156:157], a[50:51], 0
    v_mfma_f32_16x16x16_bf16 v[104:107], v[158:159], a[50:51], 0
    v_mfma_f32_16x16x16_bf16 v[108:111], v[156:157], a[52:53], 0
    v_mfma_f32_16x16x16_bf16 v[112:115], v[158:159], a[52:53], 0
    v_mfma_f32_16x16x16_bf16 v[116:119], v[156:157], a[54:55], 0
    v_mfma_f32_16x16x16_bf16 v[120:123], v[158:159], a[54:55], 0
    v_mfma_f32_16x16x16_bf16 v[124:127], v[156:157], a[56:57], 0
    v_mfma_f32_16x16x16_bf16 v[128:131], v[158:159], a[56:57], 0
    s_setprio 2
    s_cmp_ge_u32 s3, 4
    s_nop 5
    s_cbranch_scc1 K2_LOOP1
K2_LOOP0:
    v_mov_b32 v26, v27
    s_mov_b32 s46, s62
    s_mov_b32 s69, s61
    s_waitcnt vmcnt(8) lgkmcnt(0)
    s_barrier
    s_cmp_eq_u32 s46, 0
    s_cbranch_scc1 K2_EXIT0
    ds_read_b128 v[36:39], v24 offset:0
    ds_read_b128 v[40:43], v24 offset:64
    ds_read_b128 v[44:47], v24 offset:128
    ds_read_b128 v[48:51], v24 offset:192
    ds_read_b128 v[52:55], v24 offset:4096
    ds_read_b128 v[56:59], v24 offset:4160
    ds_read_b128 v[60:63], v24 offset:4224
    ds_read_b128 v[64:67], v24 offset:4288
    s_add_u32 s66, s40, 3
    v_readlane_b32 s65, v15, s66
    s_nop 0
    s_and_b32 s66, s65, 0x3ff
    s_lshl_b32 s66, s66, 2
    v_add_u32 v31, s66, v13
    ds_read2_b32 v[190:191], v31 offset0:16 offset1:0
    s_bfe_u32 s64, s65, 0x6000a
    s_sub_i32 s63, s64, 16
    s_waitcnt lgkmcnt(5)
    v_mfma_f32_16x16x32_bf16 v[76:79], v[36:39], a[16:19], 0
    v_mfma_f32_16x16x32_bf16 v[76:79], v[40:43], a[20:23], v[76:79]
    v_mfma_f32_16x16x32_bf16 v[76:79], v[44:47], a[24:27], v[76:79]
    v_mfma_f32_16x16x32_bf16 v[76:79], v[48:51], a[28:31], v[76:79]
    s_waitcnt lgkmcnt(1)
    v_mfma_f32_16x16x32_bf16 v[80:83], v[52:55], a[16:19], 0
    ds_read_b64_tr_b16 v[144:145], v25 offset:0
    ds_read_b64_tr_b16 v[146:147], v25 offset:4096
    v_mfma_f32_16x16x32_bf16 v[80:83], v[56:59], a[20:23], v[80:83]
    ds_read_b64_tr_b16 v[148:149], v25 offset:1024
    ds_read_b64_tr_b16 v[150:151], v25 offset:5120
    v_mfma_f32_16x16x32_bf16 v[80:83], v[60:63], a[24:27], v[80:83]
    ds_read_b64_tr_b16 v[152:153], v25 offset:2048
    ds_read_b64_tr_b16 v[154:155], v25 offset:6144
    v_mfma_f32_16x16x32_bf16 v[80:83], v[64:67], a[28:31], v[80:83]
    ds_read_b64 v[180:181], v26 offset:0
    ds_read_b64 v[182:183], v26 offset:256
    v_mfma_f32_16x16x32_bf16 v[84:87], v[36:39], a[32:35], 0
    ds_read_b64 v[184:185], v26 offset:512
    ds_read_b64 v[186:187], v26 offset:768
    v_mfma_f32_16x16x32_bf16 v[84:87], v[40:43], a[36:39], v[84:87]
    v_mfma_f32_16x16x32_bf16 v[84:87], v[44:47], a[40:43], v[84:87]
    s_bitcmp1_b32 s46, 1
    s_cselect_b32 s66, s45, 0
    s_sub_u32 s67, s66, s57
    s_add_u32 s56, s44, s67
    v_mfma_f32_16x16x32_bf16 v[84:87], v[48:51], a[44:47], v[84:87]
    v_cmp_gt_u32 s[76:77], s66, v2
    s_add_u32 s40, s40, 1
    s_add_u32 s59, s59, s67
    v_mfma_f32_16x16x32_bf16 v[88:91], v[52:55], a[32:35], 0
    v_readlane_b32 s65, v15, s40
    s_add_u32 s61, s41, s51
    s_add_u32 s41, s41, 33024
    v_mfma_f32_16x16x32_bf16 v[88:91], v[56:59], a[36:39], v[88:91]
    s_cmp_eq_u32 s41, 140672
    s_cselect_b32 s41, 41600, s41
    s_and_b32 s43, s65, 0x3ff
    v_mfma_f32_16x16x32_bf16 v[88:91], v[60:63], a[40:43], v[88:91]
    v_mfma_f32_16x16x32_bf16 v[88:91], v[64:67], a[44:47], v[88:91]
    v_mfma_f32_16x16x32_bf16 v[68:71], v[36:39], a[0:3], 0
    v_add_u32 v24, s41, v4
    s_bfe_u32 s44, s65, 0x70010
    s_bfe_u32 s45, s65, 0x40017
    s_bfe_u32 s57, s65, 0x1001b
    v_mfma_f32_16x16x32_bf16 v[68:71], v[40:43], a[4:7], v[68:71]
    v_add_u32 v25, s41, v7
    s_lshr_b32 s62, s65, 28
    s_lshl_b32 s66, s44, 2
    v_mfma_f32_16x16x32_bf16 v[68:71], v[44:47], a[8:11], v[68:71]
    v_add_u32 v18, s66, v11
    s_lshl_b32 s66, s43, 5
    s_cmp_ge_u32 s59, 40
    v_mfma_f32_16x16x32_bf16 v[68:71], v[48:51], a[12:15], v[68:71]
    v_add_u32 v19, s66, v8
    s_cselect_b32 s66, 40, 0
    s_sub_u32 s59, s59, s66
    v_mfma_f32_16x16x32_bf16 v[72:75], v[52:55], a[0:3], 0
    v_add_u32 v27, s59, v2
    v_subrev_u32 v34, 40, v27
    v_mfma_f32_16x16x32_bf16 v[72:75], v[56:59], a[4:7], v[72:75]
    v_min_u32 v27, v27, v34
    v_mad_u32_u24 v27, v27, s55, v9
    v_mfma_f32_16x16x32_bf16 v[72:75], v[60:63], a[8:11], v[72:75]
    ds_read_b64 v[156:157], v19
    ds_read_b64 v[158:159], v19 offset:128
    v_mfma_f32_16x16x32_bf16 v[72:75], v[64:67], a[12:15], v[72:75]
    ds_read2_b32 v[28:29], v18 offset0:0 offset1:1
    s_setprio 0
    s_mov_b32 m0, s69
    s_nop 0
    buffer_load_dwordx4 v5, s[4:7], 0 offen lds
    v_mul_f32 v100, v76, v100
    v_mul_f32 v101, v77, v101
    v_mul_f32 v102, v78, v102
    v_mul_f32 v103, v79, v103
    v_mul_f32 v104, v80, v104
    v_mul_f32 v105, v81, v105
    v_mul_f32 v106, v82, v106
    v_mul_f32 v107, v83, v107
    v_mul_f32 v108, v84, v108
    v_mul_f32 v109, v85, v109
    v_mul_f32 v110, v86, v110
    v_mul_f32 v111, v87, v111
    v_mul_f32 v112, v88, v112
    v_mul_f32 v113, v89, v113
    v_mul_f32 v114, v90, v114
    v_mul_f32 v115, v91, v115
    s_add_u32 m0, s69, 16512
    s_nop 0
    buffer_load_dwordx4 v188, s[4:7], 0 offen lds
    v_mul_f32 v116, v84, v116
    v_mul_f32 v117, v85, v117
    v_mul_f32 v118, v86, v118
    v_mul_f32 v119, v87, v119
    v_mul_f32 v120, v88, v120
    v_mul_f32 v121, v89, v121
    v_mul_f32 v122, v90, v122
    v_mul_f32 v123, v91, v123
    v_mul_f32 v124, v84, v124
    v_mul_f32 v125, v85, v125
    v_mul_f32 v126, v86, v126
    v_mul_f32 v127, v87, v127
    v_mul_f32 v128, v88, v128
    v_mul_f32 v129, v89, v129
    v_mul_f32 v130, v90, v130
    v_mul_f32 v131, v91, v131
    s_add_u32 m0, s69, 1024
    s_nop 0
    buffer_load_dwordx4 v6, s[8:11], 0 offen offset:0 lds
    s_waitcnt lgkmcnt(3)
    v_lshlrev_b32 v132, 16, v144
    v_and_b32 v133, s88, v144
    v_lshlrev_b32 v134, 16, v145
    v_and_b32 v135, s88, v145
    v_lshlrev_b32 v136, 16, v146
    v_and_b32 v137, s88, v146
    v_lshlrev_b32 v138, 16, v147
    v_and_b32 v139, s88, v147
    v_lshlrev_b32 v140, 16, v148
    v_and_b32 v141, s88, v148
    v_lshlrev_b32 v142, 16, v149
    v_and_b32 v143, s88, v149
    s_add_u32 m0, s69, 17536
    s_nop 0
    buffer_load_dwordx4 v189, s[8:11], 0 offen offset:0 lds
    v_lshlrev_b32 v144, 16, v150
    v_and_b32 v145, s88, v150
    v_lshlrev_b32 v146, 16, v151
    v_and_b32 v147, s88, v151
    v_lshlrev_b32 v148, 16, v152
    v_and_b32 v149, s88, v152
    v_lshlrev_b32 v150, 16, v153
    v_and_b32 v151, s88, v153
    v_lshlrev_b32 v152, 16, v154
    v_and_b32 v153, s88, v154
    v_lshlrev_b32 v154, 16, v155
    v_and_b32 v155, s88, v155
    s_bitcmp1_b32 s46, 0
    s_nop 0
    s_cbranch_scc0 K2_NOINIT_5
    v_lshlrev_b32 v164, 16, v180
    v_and_b32 v165, s88, v180
    v_lshlrev_b32 v166, 16, v181
    v_and_b32 v167, s88, v181
    v_lshlrev_b32 v168, 16, v182
    v_and_b32 v169, s88, v182
    v_lshlrev_b32 v170, 16, v183
    v_and_b32 v171, s88, v183
    v_lshlrev_b32 v172, 16, v184
    v_and_b32 v173, s88, v184
    v_lshlrev_b32 v174, 16, v185
    v_and_b32 v175, s88, v185
    v_lshlrev_b32 v176, 16, v186
    v_and_b32 v177, s88, v186
    v_lshlrev_b32 v178, 16, v187
    v_and_b32 v179, s88, v187
    s_nop 1
K2_NOINIT_5:
    s_add_u32 m0, s69, 1792
    s_nop 0
    buffer_load_dwordx4 v6, s[8:11], 0 offen offset:256 lds
    v_fmac_f32 v108, v100, v132
    v_fmac_f32 v109, v101, v133
    v_fmac_f32 v110, v102, v134
    v_fmac_f32 v111, v103, v135
    v_fmac_f32 v112, v104, v136
    v_fmac_f32 v113, v105, v137
    v_fmac_f32 v114, v106, v138
    v_fmac_f32 v115, v107, v139
    v_fmac_f32 v116, v100, v140
    v_fmac_f32 v117, v101, v141
    v_fmac_f32 v118, v102, v142
    v_fmac_f32 v119, v103, v143
    s_add_u32 m0, s69, 18304
    s_nop 0
    buffer_load_dwordx4 v189, s[8:11], 0 offen offset:256 lds
    v_fmac_f32 v120, v104, v144
    v_fmac_f32 v121, v105, v145
    v_fmac_f32 v122, v106, v146
    v_fmac_f32 v123, v107, v147
    v_fmac_f32 v124, v100, v148
    v_fmac_f32 v125, v101, v149
    v_fmac_f32 v126, v102, v150
    v_fmac_f32 v127, v103, v151
    v_fmac_f32 v128, v104, v152
    v_fmac_f32 v129, v105, v153
    v_fmac_f32 v130, v106, v154
    v_fmac_f32 v131, v107, v155
    s_add_u32 m0, s69, 2560
    s_nop 0
    buffer_load_dwordx4 v6, s[8:11], 0 offen offset:512 lds
    v_mul_f32 v92, v68, v92
    v_mul_f32 v93, v69, v93
    v_mul_f32 v94, v70, v94
    v_mul_f32 v95, v71, v95
    v_mul_f32 v96, v72, v96
    v_mul_f32 v97, v73, v97
    v_mul_f32 v98, v74, v98
    v_mul_f32 v99, v75, v99
    s_waitcnt lgkmcnt(0)
    v_add_u32 v30, s43, v12
    v_sub_u32 v28, v28, v30
    v_sub_u32 v29, v29, v30
    v_med3_i32 v28, v28, 0, 8
    v_med3_i32 v29, v29, 0, 8
    v_mad_u32_u24 v28, v28, 9, v29
    v_lshlrev_b32 v28, 4, v28
    v_add_u32 v28, 160256, v28
    s_add_u32 m0, s69, 19072
    s_nop 0
    buffer_load_dwordx4 v189, s[8:11], 0 offen offset:512 lds
    s_setprio 2
    v_cvt_pk_bf16_f32 v40, v108, v109
    v_cvt_pk_bf16_f32 v41, v110, v111
    v_cvt_pk_bf16_f32 v42, v112, v113
    v_cvt_pk_bf16_f32 v43, v114, v115
    s_nop 1
    v_mfma_f32_16x16x32_bf16 v[168:171], v[40:43], v[160:163], v[168:171]
    v_cvt_pk_bf16_f32 v44, v116, v117
    v_cvt_pk_bf16_f32 v45, v118, v119
    v_cvt_pk_bf16_f32 v46, v120, v121
    v_cvt_pk_bf16_f32 v47, v122, v123
    s_nop 1
    v_mfma_f32_16x16x32_bf16 v[172:175], v[44:47], v[160:163], v[172:175]
    v_cvt_pk_bf16_f32 v48, v124, v125
    v_cvt_pk_bf16_f32 v49, v126, v127
    v_cvt_pk_bf16_f32 v50, v128, v129
    v_cvt_pk_bf16_f32 v51, v130, v131
    s_nop 1
    v_mfma_f32_16x16x32_bf16 v[176:179], v[48:51], v[160:163], v[176:179]
    v_cvt_pk_bf16_f32 v36, v92, v93
    v_cvt_pk_bf16_f32 v37, v94, v95
    v_cvt_pk_bf16_f32 v38, v96, v97
    v_cvt_pk_bf16_f32 v39, v98, v99
    s_nop 1
    v_mfma_f32_16x16x32_bf16 v[164:167], v[36:39], v[160:163], v[164:167]
    ds_read_b128 v[160:163], v28
    s_mov_b64 exec, s[76:77]
    v_cvt_pk_bf16_f32 v54, v168, v169
    v_cvt_pk_bf16_f32 v55, v170, v171
    ds_write_b64 v26, v[54:55] offset:256
    v_cvt_pk_bf16_f32 v56, v172, v173
    v_cvt_pk_bf16_f32 v57, v174, v175
    ds_write_b64 v26, v[56:57] offset:512
    v_cvt_pk_bf16_f32 v58, v176, v177
    v_cvt_pk_bf16_f32 v59, v178, v179
    ds_write_b64 v26, v[58:59] offset:768
    v_cvt_pk_bf16_f32 v52, v164, v165
    v_cvt_pk_bf16_f32 v53, v166, v167
    ds_write_b64 v26, v[52:53] offset:0
    s_mov_b64 exec, -1
    s_setprio 0
    v_mfma_f32_16x16x16_bf16 v[92:95], v[156:157], a[48:49], 0
    v_cmp_gt_u32 vcc, s64, v14
    v_cmp_gt_i32 s[66:67], s63, v14
    v_mfma_f32_16x16x16_bf16 v[96:99], v[158:159], a[48:49], 0
    v_and_b32 v190, 0xffff, v190
    v_and_b32 v191, 0xffff, v191
    v_mfma_f32_16x16x16_bf16 v[100:103], v[156:157], a[50:51], 0
    v_lshl_add_u32 v5, v191, 8, v16
    v_lshl_add_u32 v6, v191, 10, v17
    v_mfma_f32_16x16x16_bf16 v[104:107], v[158:159], a[50:51], 0
    v_lshl_add_u32 v188, v190, 8, v16
    v_lshl_add_u32 v189, v190, 10, v17
    v_mfma_f32_16x16x16_bf16 v[108:111], v[156:157], a[52:53], 0
    v_cndmask_b32 v5, v23, v5, vcc
    v_cndmask_b32 v6, v23, v6, vcc
    v_mfma_f32_16x16x16_bf16 v[112:115], v[158:159], a[52:53], 0
    v_cndmask_b32 v188, v23, v188, s[66:67]
    v_cndmask_b32 v189, v23, v189, s[66:67]
    v_mfma_f32_16x16x16_bf16 v[116:119], v[156:157], a[54:55], 0
    v_mfma_f32_16x16x16_bf16 v[120:123], v[158:159], a[54:55], 0
    v_mfma_f32_16x16x16_bf16 v[124:127], v[156:157], a[56:57], 0
    v_mfma_f32_16x16x16_bf16 v[128:131], v[158:159], a[56:57], 0
    s_setprio 2
    s_nop 6
    s_branch K2_LOOP0
K2_LOOP1:
    v_mov_b32 v26, v27
    s_mov_b32 s46, s62
    s_mov_b32 s69, s61
    s_waitcnt vmcnt(8) lgkmcnt(0)
    s_barrier
    s_cmp_eq_u32 s46, 0
    s_cbranch_scc1 K2_EXIT1
    s_setprio 3
    v_mfma_f32_16x16x16_bf16 v[92:95], v[156:157], a[48:49], 0
    v_mfma_f32_16x16x16_bf16 v[96:99], v[158:159], a[48:49], 0
    v_mfma_f32_16x16x16_bf16 v[100:103], v[156:157], a[50:51], 0
    v_mfma_f32_16x16x16_bf16 v[104:107], v[158:159], a[50:51], 0
    v_mfma_f32_16x16x16_bf16 v[108:111], v[156:157], a[52:53], 0
    v_mfma_f32_16x16x16_bf16 v[112:115], v[158:159], a[52:53], 0
    v_mfma_f32_16x16x16_bf16 v[116:119], v[156:157], a[54:55], 0
    v_mfma_f32_16x16x16_bf16 v[120:123], v[158:159], a[54:55], 0
    v_mfma_f32_16x16x16_bf16 v[124:127], v[156:157], a[56:57], 0
    ds_read_b128 v[180:183], v32
    ds_read_b128 v[184:187], v33
    v_mfma_f32_16x16x16_bf16 v[128:131], v[158:159], a[56:57], 0
    ds_read_b128 v[188:191], v34
    ds_read_b128 v[192:195], v35
    s_setprio 1
    ds_read_b64 v[132:133], v26 offset:0
    ds_read_b64 v[134:135], v26 offset:256
    ds_read_b64 v[136:137], v26 offset:512
    ds_read_b64 v[138:139], v26 offset:768
    s_waitcnt lgkmcnt(4)
    ds_read_b128 v[36:39], v24 offset:0
    ds_read_b128 v[40:43], v24 offset:64
    ds_read_b128 v[44:47], v24 offset:128
    ds_read_b128 v[48:51], v24 offset:192
    ds_read_b128 v[52:55], v24 offset:4096
    ds_read_b128 v[56:59], v24 offset:4160
    ds_read_b128 v[60:63], v24 offset:4224
    ds_read_b128 v[64:67], v24 offset:4288
    s_cmp_lt_u32 s49, s56
    s_cbranch_scc0 K2_OD_6_0
    buffer_store_dwordx4 v[180:183], v10, s[12:15], s54 offen sc1
    s_add_u32 s68, s54, 40960
    s_mov_b32 m0, s53
    s_add_u32 s49, s49, 4
    buffer_load_dwordx4 v10, s[24:27], s68 offen nt lds
    s_add_u32 s54, s54, 4096
    s_mov_b32 s53, s71
    s_cmp_lt_u32 s49, s56
    s_cbranch_scc0 K2_OD_6_1
    buffer_store_dwordx4 v[184:187], v10, s[12:15], s54 offen sc1
    s_add_u32 s68, s54, 40960
    s_mov_b32 m0, s53
    s_add_u32 s49, s49, 4
    buffer_load_dwordx4 v10, s[24:27], s68 offen nt lds
    s_add_u32 s54, s54, 4096
    s_mov_b32 s53, s72
    s_cmp_lt_u32 s49, s56
    s_cbranch_scc0 K2_OD_6_2
    buffer_store_dwordx4 v[188:191], v10, s[12:15], s54 offen sc1
    s_add_u32 s68, s54, 40960
    s_mov_b32 m0, s53
    s_add_u32 s49, s49, 4
    buffer_load_dwordx4 v10, s[24:27], s68 offen nt lds
    s_add_u32 s54, s54, 4096
    s_mov_b32 s53, s73
    s_cmp_lt_u32 s49, s56
    s_cbranch_scc0 K2_OD_6_3
    buffer_store_dwordx4 v[192:195], v10, s[12:15], s54 offen sc1
    s_add_u32 s68, s54, 40960
    s_mov_b32 m0, s53
    s_add_u32 s49, s49, 4
    buffer_load_dwordx4 v10, s[24:27], s68 offen nt lds
    s_add_u32 s54, s54, 4096
    s_mov_b32 s53, s74
    s_branch K2_OD_6
K2_OD_6_0:
    buffer_load_dword v22, v23, s[8:11], 0 offen
    buffer_load_dword v22, v23, s[8:11], 0 offen
K2_OD_6_1:
    buffer_load_dword v22, v23, s[8:11], 0 offen
    buffer_load_dword v22, v23, s[8:11], 0 offen
K2_OD_6_2:
    buffer_load_dword v22, v23, s[8:11], 0 offen
    buffer_load_dword v22, v23, s[8:11], 0 offen
K2_OD_6_3:
    buffer_load_dword v22, v23, s[8:11], 0 offen
    buffer_load_dword v22, v23, s[8:11], 0 offen
K2_OD_6:
    ds_read_b64_tr_b16 v[144:145], v25 offset:0
    ds_read_b64_tr_b16 v[146:147], v25 offset:4096
    ds_read_b64_tr_b16 v[148:149], v25 offset:1024
    ds_read_b64_tr_b16 v[150:151], v25 offset:5120
    ds_read_b64_tr_b16 v[152:153], v25 offset:2048
    ds_read_b64_tr_b16 v[154:155], v25 offset:6144
    s_waitcnt lgkmcnt(14)
    s_bitcmp1_b32 s46, 0
    s_cbranch_scc0 K2_NOINIT_7
    v_lshlrev_b32 v164, 16, v132
    v_and_b32 v165, s88, v132
    v_lshlrev_b32 v166, 16, v133
    v_and_b32 v167, s88, v133
    v_lshlrev_b32 v168, 16, v134
    v_and_b32 v169, s88, v134
    v_lshlrev_b32 v170, 16, v135
    v_and_b32 v171, s88, v135
    v_lshlrev_b32 v172, 16, v136
    v_and_b32 v173, s88, v136
    v_lshlrev_b32 v174, 16, v137
    v_and_b32 v175, s88, v137
    v_lshlrev_b32 v176, 16, v138
    v_and_b32 v177, s88, v138
    v_lshlrev_b32 v178, 16, v139
    v_and_b32 v179, s88, v139
    s_nop 1
K2_NOINIT_7:
    s_waitcnt lgkmcnt(6)
    v_mfma_f32_16x16x32_bf16 v[76:79], v[36:39], a[16:19], 0
    s_bitcmp1_b32 s46, 1
    s_cselect_b32 s66, s45, 0
    s_sub_u32 s67, s66, s57
    s_add_u32 s56, s44, s67
    v_mfma_f32_16x16x32_bf16 v[76:79], v[40:43], a[20:23], v[76:79]
    v_cmp_gt_u32 s[76:77], s66, v2
    s_add_u32 s40, s40, 1
    s_add_u32 s59, s59, s67
    v_mfma_f32_16x16x32_bf16 v[76:79], v[44:47], a[24:27], v[76:79]
    v_readlane_b32 s65, v15, s40
    s_add_u32 s61, s41, s51
    s_add_u32 s41, s41, 33024
    v_mfma_f32_16x16x32_bf16 v[76:79], v[48:51], a[28:31], v[76:79]
    s_cmp_eq_u32 s41, 140672
    s_cselect_b32 s41, 41600, s41
    s_and_b32 s43, s65, 0x3ff
    v_mfma_f32_16x16x32_bf16 v[80:83], v[52:55], a[16:19], 0
    v_add_u32 v24, s41, v4
    s_bfe_u32 s44, s65, 0x70010
    s_bfe_u32 s45, s65, 0x40017
    s_bfe_u32 s57, s65, 0x1001b
    v_mfma_f32_16x16x32_bf16 v[80:83], v[56:59], a[20:23], v[80:83]
    v_add_u32 v25, s41, v7
    s_lshr_b32 s62, s65, 28
    s_lshl_b32 s66, s44, 2
    v_mfma_f32_16x16x32_bf16 v[80:83], v[60:63], a[24:27], v[80:83]
    v_add_u32 v18, s66, v11
    s_lshl_b32 s66, s43, 5
    s_cmp_ge_u32 s59, 40
    v_mfma_f32_16x16x32_bf16 v[80:83], v[64:67], a[28:31], v[80:83]
    v_add_u32 v19, s66, v8
    s_cselect_b32 s66, 40, 0
    s_sub_u32 s59, s59, s66
    v_mfma_f32_16x16x32_bf16 v[84:87], v[36:39], a[32:35], 0
    v_add_u32 v27, s59, v2
    v_subrev_u32 v34, 40, v27
    v_mfma_f32_16x16x32_bf16 v[84:87], v[40:43], a[36:39], v[84:87]
    v_min_u32 v27, v27, v34
    v_mad_u32_u24 v27, v27, s55, v9
    v_mfma_f32_16x16x32_bf16 v[84:87], v[44:47], a[40:43], v[84:87]
    ds_read_b64 v[156:157], v19
    ds_read_b64 v[158:159], v19 offset:128
    ds_read2_b32 v[28:29], v18 offset0:0 offset1:1
    v_mfma_f32_16x16x32_bf16 v[84:87], v[48:51], a[44:47], v[84:87]
    v_mul_f32 v100, v76, v100
    v_mfma_f32_16x16x32_bf16 v[88:91], v[52:55], a[32:35], 0
    v_mul_f32 v101, v77, v101
    v_mfma_f32_16x16x32_bf16 v[88:91], v[56:59], a[36:39], v[88:91]
    v_mul_f32 v102, v78, v102
    v_mfma_f32_16x16x32_bf16 v[88:91], v[60:63], a[40:43], v[88:91]
    v_mul_f32 v103, v79, v103
    v_mfma_f32_16x16x32_bf16 v[88:91], v[64:67], a[44:47], v[88:91]
    v_mul_f32 v104, v80, v104
    v_mfma_f32_16x16x32_bf16 v[68:71], v[36:39], a[0:3], 0
    v_mul_f32 v105, v81, v105
    v_mfma_f32_16x16x32_bf16 v[68:71], v[40:43], a[4:7], v[68:71]
    v_mul_f32 v106, v82, v106
    v_mfma_f32_16x16x32_bf16 v[68:71], v[44:47], a[8:11], v[68:71]
    v_mul_f32 v107, v83, v107
    v_mfma_f32_16x16x32_bf16 v[68:71], v[48:51], a[12:15], v[68:71]
    v_cvt_pk_bf16_f32 v100, v100, 0
    v_mfma_f32_16x16x32_bf16 v[72:75], v[52:55], a[0:3], 0
    v_cvt_pk_bf16_f32 v101, 0, v101
    v_mfma_f32_16x16x32_bf16 v[72:75], v[56:59], a[4:7], v[72:75]
    v_cvt_pk_bf16_f32 v102, v102, 0
    v_mfma_f32_16x16x32_bf16 v[72:75], v[60:63], a[8:11], v[72:75]
    v_cvt_pk_bf16_f32 v103, 0, v103
    v_mfma_f32_16x16x32_bf16 v[72:75], v[64:67], a[12:15], v[72:75]
    v_cvt_pk_bf16_f32 v104, v104, 0
    s_setprio 1
    v_cvt_pk_bf16_f32 v105, 0, v105
    v_cvt_pk_bf16_f32 v106, v106, 0
    v_cvt_pk_bf16_f32 v107, 0, v107
    v_mul_f32 v108, v84, v108
    v_mul_f32 v109, v85, v109
    v_mul_f32 v110, v86, v110
    v_mul_f32 v111, v87, v111
    v_mul_f32 v112, v88, v112
    v_mul_f32 v113, v89, v113
    v_mul_f32 v114, v90, v114
    v_mul_f32 v115, v91, v115
    v_mul_f32 v116, v84, v116
    v_mul_f32 v117, v85, v117
    v_mul_f32 v118, v86, v118
    v_mul_f32 v119, v87, v119
    v_mul_f32 v120, v88, v120
    v_mul_f32 v121, v89, v121
    v_mul_f32 v122, v90, v122
    v_mul_f32 v123, v91, v123
    v_mul_f32 v124, v84, v124
    v_mul_f32 v125, v85, v125
    v_mul_f32 v126, v86, v126
    v_mul_f32 v127, v87, v127
    v_mul_f32 v128, v88, v128
    v_mul_f32 v129, v89, v129
    v_mul_f32 v130, v90, v130
    v_mul_f32 v131, v91, v131
    s_waitcnt lgkmcnt(0)
    v_dot2_f32_bf16 v108, v144, v100, v108
    v_dot2_f32_bf16 v109, v144, v101, v109
    v_dot2_f32_bf16 v110, v145, v102, v110
    v_dot2_f32_bf16 v111, v145, v103, v111
    v_dot2_f32_bf16 v112, v146, v104, v112
    v_dot2_f32_bf16 v113, v146, v105, v113
    v_dot2_f32_bf16 v114, v147, v106, v114
    v_dot2_f32_bf16 v115, v147, v107, v115
    v_add_u32 v32, s53, v10
    s_add_u32 s66, s53, 4160
    s_cmp_ge_u32 s66, 41600
    s_cselect_b32 s68, 41600, 0
    s_sub_u32 s71, s66, s68
    v_dot2_f32_bf16 v116, v148, v100, v116
    v_dot2_f32_bf16 v117, v148, v101, v117
    v_dot2_f32_bf16 v118, v149, v102, v118
    v_dot2_f32_bf16 v119, v149, v103, v119
    v_dot2_f32_bf16 v120, v150, v104, v120
    v_dot2_f32_bf16 v121, v150, v105, v121
    v_dot2_f32_bf16 v122, v151, v106, v122
    v_dot2_f32_bf16 v123, v151, v107, v123
    v_add_u32 v33, s71, v10
    s_add_u32 s66, s71, 4160
    s_cmp_ge_u32 s66, 41600
    s_cselect_b32 s68, 41600, 0
    s_sub_u32 s72, s66, s68
    v_dot2_f32_bf16 v124, v152, v100, v124
    v_dot2_f32_bf16 v125, v152, v101, v125
    v_dot2_f32_bf16 v126, v153, v102, v126
    v_dot2_f32_bf16 v127, v153, v103, v127
    v_dot2_f32_bf16 v128, v154, v104, v128
    v_dot2_f32_bf16 v129, v154, v105, v129
    v_dot2_f32_bf16 v130, v155, v106, v130
    v_dot2_f32_bf16 v131, v155, v107, v131
    v_add_u32 v34, s72, v10
    s_add_u32 s66, s72, 4160
    s_cmp_ge_u32 s66, 41600
    s_cselect_b32 s68, 41600, 0
    s_sub_u32 s73, s66, s68
    v_mul_f32 v92, v68, v92
    v_mul_f32 v93, v69, v93
    v_mul_f32 v94, v70, v94
    v_mul_f32 v95, v71, v95
    v_mul_f32 v96, v72, v96
    v_mul_f32 v97, v73, v97
    v_mul_f32 v98, v74, v98
    v_mul_f32 v99, v75, v99
    v_add_u32 v35, s73, v10
    s_add_u32 s66, s73, 4160
    s_cmp_ge_u32 s66, 41600
    s_cselect_b32 s68, 41600, 0
    s_sub_u32 s74, s66, s68
    v_add_u32 v30, s43, v12
    v_sub_u32 v28, v28, v30
    v_sub_u32 v29, v29, v30
    v_med3_i32 v28, v28, 0, 8
    v_med3_i32 v29, v29, 0, 8
    v_mad_u32_u24 v28, v28, 9, v29
    v_lshlrev_b32 v28, 4, v28
    v_add_u32 v28, 160256, v28
    s_setprio 2
    v_cvt_pk_bf16_f32 v40, v108, v109
    v_cvt_pk_bf16_f32 v41, v110, v111
    v_cvt_pk_bf16_f32 v42, v112, v113
    v_cvt_pk_bf16_f32 v43, v114, v115
    s_nop 1
    v_mfma_f32_16x16x32_bf16 v[168:171], v[40:43], v[160:163], v[168:171]
    v_cvt_pk_bf16_f32 v44, v116, v117
    v_cvt_pk_bf16_f32 v45, v118, v119
    v_cvt_pk_bf16_f32 v46, v120, v121
    v_cvt_pk_bf16_f32 v47, v122, v123
    s_nop 1
    v_mfma_f32_16x16x32_bf16 v[172:175], v[44:47], v[160:163], v[172:175]
    v_cvt_pk_bf16_f32 v48, v124, v125
    v_cvt_pk_bf16_f32 v49, v126, v127
    v_cvt_pk_bf16_f32 v50, v128, v129
    v_cvt_pk_bf16_f32 v51, v130, v131
    s_nop 1
    v_mfma_f32_16x16x32_bf16 v[176:179], v[48:51], v[160:163], v[176:179]
    v_cvt_pk_bf16_f32 v36, v92, v93
    v_cvt_pk_bf16_f32 v37, v94, v95
    v_cvt_pk_bf16_f32 v38, v96, v97
    v_cvt_pk_bf16_f32 v39, v98, v99
    s_nop 1
    v_mfma_f32_16x16x32_bf16 v[164:167], v[36:39], v[160:163], v[164:167]
    ds_read_b128 v[160:163], v28
    s_mov_b64 exec, s[76:77]
    v_cvt_pk_bf16_f32 v54, v168, v169
    v_cvt_pk_bf16_f32 v55, v170, v171
    ds_write_b64 v26, v[54:55] offset:256
    v_cvt_pk_bf16_f32 v56, v172, v173
    v_cvt_pk_bf16_f32 v57, v174, v175
    ds_write_b64 v26, v[56:57] offset:512
    v_cvt_pk_bf16_f32 v58, v176, v177
    v_cvt_pk_bf16_f32 v59, v178, v179
    ds_write_b64 v26, v[58:59] offset:768
    v_cvt_pk_bf16_f32 v52, v164, v165
    v_cvt_pk_bf16_f32 v53, v166, v167
    ds_write_b64 v26, v[52:53] offset:0
    s_mov_b64 exec, -1
    s_branch K2_LOOP1
K2_EXIT1:
    ds_read_b128 v[180:183], v32
    ds_read_b128 v[184:187], v33
    ds_read_b128 v[188:191], v34
    ds_read_b128 v[192:195], v35
    s_waitcnt lgkmcnt(0)
    s_cmp_lt_u32 s49, s56
    s_cbranch_scc0 K2_EXIT0
    buffer_store_dwordx4 v[180:183], v10, s[12:15], s54 offen sc1
    s_add_u32 s49, s49, 4
    s_add_u32 s54, s54, 4096
    s_mov_b32 s53, s71
    s_cmp_lt_u32 s49, s56
    s_cbranch_scc0 K2_EXIT0
    buffer_store_dwordx4 v[184:187], v10, s[12:15], s54 offen sc1
    s_add_u32 s49, s49, 4
    s_add_u32 s54, s54, 4096
    s_mov_b32 s53, s72
    s_cmp_lt_u32 s49, s56
    s_cbranch_scc0 K2_EXIT0
    buffer_store_dwordx4 v[188:191], v10, s[12:15], s54 offen sc1
    s_add_u32 s49, s49, 4
    s_add_u32 s54, s54, 4096
    s_mov_b32 s53, s73
    s_cmp_lt_u32 s49, s56
    s_cbranch_scc0 K2_EXIT0
    buffer_store_dwordx4 v[192:195], v10, s[12:15], s54 offen sc1
    s_add_u32 s49, s49, 4
    s_add_u32 s54, s54, 4096
    s_mov_b32 s53, s74
K2_EXIT0:
K2_PASS_DONE:
    s_waitcnt vmcnt(0)
    s_cmp_eq_u32 s91, 0
    s_cbranch_scc1 K2_END
    s_lshl_b32 s74, s91, 9
    s_cmp_ge_u32 s74, s93
    s_cbranch_scc1 K2_END
    s_mov_b32 s24, s12
    s_mov_b32 s25, s13
    s_setprio 0
    s_barrier
    buffer_inv sc1
    s_waitcnt vmcnt(0)
    s_branch K2_NEXTPASS
K2_SLOW:
    v_and_b32 v64, 3, v0
    v_cmp_eq_u32 vcc, 0, v64
    v_mov_b32 v65, 162644
    v_add_u32 v66, 158080, v0
    s_mov_b64 exec, vcc
    ds_add_u32 v65, v36
    ds_write_b32 v66, v36
    s_mov_b64 exec, -1
    v_mov_b32 v67, 0
    ds_write_b32 v65, v67 offset:4
    s_waitcnt lgkmcnt(0)
    s_barrier
    s_cmp_lg_u32 s3, 0
    s_cbranch_scc1 K2_S1
    ds_read_b32 v68, v65
    s_mov_b64 exec, 1
    s_waitcnt lgkmcnt(0)
    buffer_atomic_add v68, v67, s[96:99], 0 offen sc0 sc1
    s_waitcnt vmcnt(0)
    ds_write_b32 v65, v68 offset:8
    s_mov_b64 exec, -1
    s_waitcnt lgkmcnt(0)
K2_S1:
    s_barrier
    ds_read_b32 v68, v65 offset:8
    ds_read_b32 v69, v65
    v_mov_b32 v67, 1
    s_waitcnt lgkmcnt(0)
    v_readfirstlane_b32 s92, v68
    v_readfirstlane_b32 s93, v69
    s_lshl_b32 s92, s92, 2
    s_add_u32 s92, s92, 5242880
    s_mov_b64 exec, s[40:41]
    s_nop 1
    s_cbranch_execz K2_SI_8
    ds_add_rtn_u32 v68, v65, v67 offset:4
    s_waitcnt lgkmcnt(0)
    v_lshlrev_b32 v68, 2, v68
    buffer_store_dword v36, v68, s[16:19], s92 offen sc0 sc1
    s_nop 0
K2_SI_8:
    s_mov_b64 exec, s[42:43]
    s_cbranch_execz K2_SI_9
    ds_add_rtn_u32 v68, v65, v67 offset:4
    s_waitcnt lgkmcnt(0)
    v_lshlrev_b32 v68, 2, v68
    buffer_store_dword v37, v68, s[16:19], s92 offen sc0 sc1
    s_nop 0
K2_SI_9:
    s_mov_b64 exec, s[44:45]
    s_cbranch_execz K2_SI_10
    ds_add_rtn_u32 v68, v65, v67 offset:4
    s_waitcnt lgkmcnt(0)
    v_lshlrev_b32 v68, 2, v68
    buffer_store_dword v38, v68, s[16:19], s92 offen sc0 sc1
    s_nop 0
K2_SI_10:
    s_mov_b64 exec, s[46:47]
    s_cbranch_execz K2_SI_11
    ds_add_rtn_u32 v68, v65, v67 offset:4
    s_waitcnt lgkmcnt(0)
    v_lshlrev_b32 v68, 2, v68
    buffer_store_dword v39, v68, s[16:19], s92 offen sc0 sc1
    s_nop 0
K2_SI_11:
    s_mov_b64 exec, -1
    s_mov_b32 s60, 0
K2_SW:
    s_lshl_b32 s61, s60, 2
    s_add_u32 s61, s61, 158080
    v_mov_b32 v68, s61
    ds_read_b32 v68, v68
    s_waitcnt lgkmcnt(0)
    v_readfirstlane_b32 s61, v68
    s_nop 0
    s_cmp_le_u32 s61, 14
    s_nop 2
    s_cbranch_scc1 K2_SWN
    s_mul_i32 s62, s60, 16384
    s_add_u32 s62, s62, 2097152
    v_mov_b32 v68, 0
    buffer_load_dword v68, v68, s[16:19], s62 offen
    s_waitcnt vmcnt(0)
    v_readfirstlane_b32 s63, v68
    v_mov_b32 v70, v0
    s_mov_b32 s64, 0
    s_nop 2
K2_SC:
    v_lshlrev_b32 v68, 2, v70
    buffer_load_dword v69, v68, s[16:19], s62 offen offset:16
    v_cmp_gt_u32 s[66:67], s63, v70
    s_waitcnt vmcnt(0)
    v_lshrrev_b32 v68, 16, v69
    v_subrev_u32 v68, s28, v68
    v_cmp_gt_u32 vcc, s29, v68
    s_nop 0
    s_and_b64 exec, vcc, s[66:67]
    s_nop 2
    s_cbranch_execz K2_SCN
    ds_add_rtn_u32 v68, v65, v67 offset:4
    s_waitcnt lgkmcnt(0)
    v_lshlrev_b32 v68, 2, v68
    buffer_store_dword v69, v68, s[16:19], s92 offen sc0 sc1
    s_nop 0
K2_SCN:
    s_mov_b64 exec, -1
    v_add_u32 v70, 512, v70
    s_add_u32 s64, s64, 512
    s_cmp_lt_u32 s64, s63
    s_cbranch_scc1 K2_SC
K2_SWN:
    s_add_u32 s60, s60, 1
    s_cmp_lt_u32 s60, 112
    s_cbranch_scc1 K2_SW
    v_lshlrev_b32 v27, 3, v1
    v_mov_b32 v84, 0
    v_mov_b32 v85, 0
    v_add_u32 v83, 161552, v27
    ds_write_b64 v83, v[84:85]
    s_lshl_b32 s60, s28, 2
    s_sub_u32 s60, 161552, s60
    s_waitcnt vmcnt(0) lgkmcnt(0)
    s_barrier
    v_mov_b32 v70, v0
    s_mov_b32 s64, 0
    s_nop 0
K2_SS_12:
    v_cmp_gt_u32 vcc, s93, v70
    s_nop 0
    s_and_b64 exec, exec, vcc
    s_nop 2
    s_cbranch_execz K2_SK_13
    v_lshlrev_b32 v68, 2, v70
    buffer_load_dword v69, v68, s[16:19], s92 offen sc0 sc1
    s_waitcnt vmcnt(0)
    v_lshrrev_b32 v68, 16, v69
    v_lshl_add_u32 v68, v68, 2, s60
    ds_add_u32 v68, v67
    s_nop 0
K2_SK_13:
    s_mov_b64 exec, -1
    v_add_u32 v70, 512, v70
    s_add_u32 s64, s64, 512
    s_cmp_lt_u32 s64, s93
    s_cbranch_scc1 K2_SS_12
    s_waitcnt vmcnt(0) lgkmcnt(0)
    s_barrier
    ds_read_b64 v[102:103], v83
    s_waitcnt lgkmcnt(0)
    v_add_u32 v104, v102, v103
    v_mov_b32 v105, v104
    s_nop 1
    v_add_u32_dpp v105, v105, v105 row_shr:1 row_mask:0xf bank_mask:0xf
    s_nop 1
    v_add_u32_dpp v105, v105, v105 row_shr:2 row_mask:0xf bank_mask:0xf
    s_nop 1
    v_add_u32_dpp v105, v105, v105 row_shr:4 row_mask:0xf bank_mask:0xf
    s_nop 1
    v_add_u32_dpp v105, v105, v105 row_shr:8 row_mask:0xf bank_mask:0xf
    s_nop 1
    v_add_u32_dpp v105, v105, v105 row_bcast:15 row_mask:0xa bank_mask:0xf
    s_nop 1
    v_add_u32_dpp v105, v105, v105 row_bcast:31 row_mask:0xc bank_mask:0xf
    v_sub_u32 v104, v105, v104
    v_add_u32 v105, v104, v102
    ds_write_b64 v83, v[104:105] offset:512
    s_add_u32 s61, s92, 12582912
    s_waitcnt lgkmcnt(0)
    s_barrier
    v_mov_b32 v70, v0
    s_mov_b32 s64, 0
    s_nop 0
K2_SS_14:
    v_cmp_gt_u32 vcc, s93, v70
    s_nop 0
    s_and_b64 exec, exec, vcc
    s_nop 2
    s_cbranch_execz K2_SK_15
    v_lshlrev_b32 v68, 2, v70
    buffer_load_dword v69, v68, s[16:19], s92 offen sc0 sc1
    s_waitcnt vmcnt(0)
    v_lshrrev_b32 v68, 16, v69
    v_lshl_add_u32 v68, v68, 2, s60
    ds_add_rtn_u32 v68, v68, v67 offset:512
    s_waitcnt lgkmcnt(0)
    v_lshlrev_b32 v68, 2, v68
    buffer_store_dword v69, v68, s[16:19], s61 offen sc0 sc1
    s_nop 0
K2_SK_15:
    s_mov_b64 exec, -1
    v_add_u32 v70, 512, v70
    s_add_u32 s64, s64, 512
    s_cmp_lt_u32 s64, s93
    s_cbranch_scc1 K2_SS_14
    s_waitcnt vmcnt(0) lgkmcnt(0)
    s_barrier
    s_mov_b32 s92, s61
K2_NEXTPASS:
    s_lshl_b32 s74, s91, 9
    v_add_u32 v64, s74, v0
    v_cmp_gt_u32 vcc, s93, v64
    v_lshlrev_b32 v64, 2, v64
    s_nop 0
    v_cndmask_b32 v64, v23, v64, vcc
    buffer_load_dword v36, v64, s[16:19], s92 offen sc0 sc1
    v_cndmask_b32 v80, 0, 1, vcc
    s_add_u32 s91, s91, 1
    s_mov_b64 s[94:95], -1
    s_mov_b64 s[70:71], 0
    v_lshlrev_b32 v27, 3, v1
    s_lshl_b32 s78, s3, 10
    v_mov_b32 v84, 0
    v_mov_b32 v85, 0
    v_add_u32 v83, 161552, v27
    ds_write_b64 v83, v[84:85]
    v_mov_b32 v83, 162640
    ds_write_b32 v83, v84
    s_waitcnt vmcnt(0) lgkmcnt(0)
    s_barrier
    s_branch K2_PASS
K2_END:
    s_endpgm
W_HUB_1:
    s_add_u32 s67, s32, 1
    s_lshr_b32 s66, s67, 1
    v_readlane_b32 s35, v20, s66
    v_readlane_b32 s68, v21, s66
    s_bitcmp1_b32 s67, 0
    s_cselect_b32 s35, s68, s35
    s_cmp_le_u32 s35, s64
    s_cselect_b32 s62, 1, 0
    s_min_u32 s64, s64, s35
    s_lshl_b32 s60, s62, 6
    s_xor_b32 s61, s33, 1
    s_lshl_b32 s61, s61, 5
    s_or_b32 s60, s60, s61
    s_or_b32 s60, s60, 0x81
    s_xor_b32 s33, s62, 1
    s_branch W_BACK_2
W_HUB_3:
    s_add_u32 s67, s32, 1
    s_lshr_b32 s66, s67, 1
    v_readlane_b32 s35, v20, s66
    v_readlane_b32 s68, v21, s66
    s_bitcmp1_b32 s67, 0
    s_cselect_b32 s35, s68, s35
    s_cmp_le_u32 s35, s64
    s_cselect_b32 s62, 1, 0
    s_min_u32 s64, s64, s35
    s_lshl_b32 s60, s62, 6
    s_xor_b32 s61, s33, 1
    s_lshl_b32 s61, s61, 5
    s_or_b32 s60, s60, s61
    s_or_b32 s60, s60, 0x81
    s_xor_b32 s33, s62, 1
    s_branch W_BACK_4
.section .rodata,"a"
.p2align 6
.amdhsa_kernel k1_kernel
  .amdhsa_next_free_vgpr 128
  .amdhsa_next_free_sgpr 96
  .amdhsa_accum_offset 128
  .amdhsa_group_segment_fixed_size 0
  .amdhsa_kernarg_size 88
  .amdhsa_user_sgpr_count 2
  .amdhsa_user_sgpr_kernarg_segment_ptr 1
  .amdhsa_system_sgpr_workgroup_id_x 1
  .amdhsa_float_denorm_mode_32 3
  .amdhsa_float_denorm_mode_16_64 3
.end_amdhsa_kernel

.p2align 6
.amdhsa_kernel k2_kernel
  .amdhsa_next_free_vgpr 254
  .amdhsa_next_free_sgpr 102
  .amdhsa_accum_offset 196
  .amdhsa_group_segment_fixed_size 0
  .amdhsa_kernarg_size 88
  .amdhsa_user_sgpr_count 2
  .amdhsa_user_sgpr_kernarg_segment_ptr 1
  .amdhsa_system_sgpr_workgroup_id_x 1
  .amdhsa_float_denorm_mode_32 3
  .amdhsa_float_denorm_mode_16_64 3
.end_amdhsa_kernel
```
